```python
import torch

def _softmax(x, axis=-1):
    return torch.softmax(x, dim=axis)

def _gelu(x):
    return torch.nn.functional.gelu(x, approximate='tanh')

def _silu(x):
    return torch.nn.functional.silu(x)

def _sigmoid(x):
    return torch.sigmoid(x)

def _layernorm(x, axis=-1, eps=1e-05):
    m = x.mean(dim=axis, keepdim=True)
    v = x.var(dim=axis, keepdim=True, unbiased=False)
    return (x - m) / torch.sqrt(v + eps)

def _scatter_add(tgt, idx, src, axis=0):
    return tgt.clone().index_add_(axis, idx, src)

def _segment_sum(src, seg, n):
    out = torch.zeros((n,) + src.shape[1:], dtype=src.dtype)
    return out.index_add_(0, seg, src)

def _pad(x, pw):
    flat = tuple((v for pair in reversed(pw) for v in pair))
    return torch.nn.functional.pad(x, flat)
kernel_name = 'adaLN_cond__sliding_block__mixer_channel_mlp__prompt'

def setup_inputs():

    _w = lambda a: (lambda t: t.to(torch.bfloat16) if t.is_floating_point() else t)(torch.as_tensor(a))

    def _A_setup():
        B, S, D = (1, 2048, 512)
        return {'x': _w((lambda *s: torch.randn(*s, dtype=torch.bfloat16) * 0.05)(B, S, D)), 'wqkv': _w((lambda *s: torch.randn(*s, dtype=torch.bfloat16) * 0.05)(D, 3 * D)), 'wo': _w((lambda *s: torch.randn(*s, dtype=torch.bfloat16) * 0.05)(D, D))}
    _A_in = _A_setup()

    def _B_setup():
        B, S, D, F = (1, 2048, 512, 1792)
        return {'x': _w((lambda *s: torch.randn(*s, dtype=torch.bfloat16) * 0.05)(B, S, D)), 'w1': _w((lambda *s: torch.randn(*s, dtype=torch.bfloat16) * 3.2)(D, F) * D ** (-0.5)), 'b1': _w((lambda *s: torch.randn(*s, dtype=torch.bfloat16) * 1.6)(F)), 'w2': _w((lambda *s: torch.randn(*s, dtype=torch.bfloat16) * 0.2)(F, D) * F ** (-0.5)), 'b2': _w((lambda *s: torch.randn(*s, dtype=torch.bfloat16) * 0.4)(D))}
    _B_in = _B_setup()
    return {'A_x': _A_in['x'], 'A_wqkv': _A_in['wqkv'], 'A_wo': _A_in['wo'], 'B_x': _B_in['x'], 'B_w1': _B_in['w1'], 'B_b1': _B_in['b1'], 'B_w2': _B_in['w2'], 'B_b2': _B_in['b2'], 'c': _w((lambda *s: torch.randn(*s, dtype=torch.bfloat16) * 0.1)(1, 512) * 8.0), 'w_mod': _w((lambda *s: torch.randn(*s, dtype=torch.bfloat16) * 0.1)(512, 6 * 512) * 512 ** (-0.5) * 8.0)}

def reference(A_x, A_wqkv, A_wo, B_x, B_w1, B_b1, B_w2, B_b2, c, w_mod):

    def _A_ref(x, wqkv, wo):
        B, S, D = x.shape
        H = 32
        Dh = D // H
        W = 256
        qkv = (lambda x, *d: x.permute(*d))((x @ wqkv).reshape(B, S, 3, H, Dh), 2, 0, 3, 1, 4)
        q, k, v = (qkv[0], qkv[1], qkv[2])
        scores = torch.einsum('bhqd,bhkd->bhqk', q, k) * Dh ** (-0.5)
        idx = torch.arange(S)
        mask = (idx[:, None] - idx[None, :] >= 0) & (idx[:, None] - idx[None, :] < W)
        scores = torch.where(mask[None, None], scores, -1000000000.0)
        p = _softmax(scores, axis=-1)
        o = torch.einsum('bhqk,bhkd->bhqd', p, v)
        return (lambda x, *d: x.permute(*d))(o, 0, 2, 1, 3).reshape(B, S, D) @ wo

    def _B_ref(x, w1, b1, w2, b2):
        y = _layernorm(x, axis=-1)
        h = _gelu(torch.einsum('bsd,df->bsf', y, w1) + b1)
        return torch.einsum('bsf,fd->bsd', h, w2) + b2
    x = A_x
    mod = (_silu(c) @ w_mod).reshape(c.shape[0], 6, 1, -1)
    sa, ca, ga, sb, cb, gb = (mod[:, 0].clone(), mod[:, 1].clone(), mod[:, 2].clone(), mod[:, 3].clone(), mod[:, 4].clone(), mod[:, 5].clone())
    h = _layernorm(x, axis=-1) * (1 + ca) + sa
    x = x + ga * _A_ref(h, A_wqkv, A_wo)
    h = _layernorm(x, axis=-1) * (1 + cb) + sb
    x = x + gb * _B_ref(h, B_w1, B_b1, B_w2, B_b2)
    return x
```

```asm
; @launch grid=(256,1,1) block=(512,1,1) lds=163840
.amdgcn_target "amdgcn-amd-amdhsa--gfx950"
.text
.globl adaLN_cond__sliding_block__mixer_channel_mlp__prompt_kernel
.p2align 8
.type adaLN_cond__sliding_block__mixer_channel_mlp__prompt_kernel,@function
adaLN_cond__sliding_block__mixer_channel_mlp__prompt_kernel:
    s_load_dwordx2 s[4:5], s[0:1], 0
    s_load_dwordx2 s[24:25], s[0:1], 64
    s_load_dwordx2 s[20:21], s[0:1], 72
    s_cmp_ge_u32 s2, 256
    s_cbranch_scc1 L_END
    v_lshrrev_b32 v3, 6, v0
    v_and_b32 v1, 63, v0
    v_readfirstlane_b32 s40, v3
    v_lshrrev_b32 v6, 3, v1
    v_and_b32 v7, 7, v1
    v_lshrrev_b32 v8, 4, v1
    v_xor_b32 v9, v7, v8
    v_lshlrev_b32_e64 v9, 4, v9
    v_lshl_add_u32 v4, v6, 10, v9
    v_xor_b32 v5, 64, v4
    s_and_b32 s41, s2, 7
    s_bfe_u32 s52, s2, 0x10003
    s_lshl1_add_u32 s43, s41, s52
    s_lshr_b32 s46, s40, 1
    s_and_b32 s47, s40, 1
    s_bfe_u32 s91, s2, 0x20005
    s_lshl2_add_u32 s51, s43, s46
    s_lshl_b32 s51, s51, 6
    s_add_u32 s51, s51, s47
    s_lshl_b32 s51, s51, 9
    s_lshl_b32 s54, s40, 14
    s_mov_b32 s6, 2097152
    s_mov_b32 s7, 0x20000
    s_mov_b32 s26, 1024
    s_mov_b32 s27, 0x20000
    s_mov_b32 s22, 3145728
    s_mov_b32 s23, 0x20000
    v_lshlrev_b32_e64 v13, 1, v6
    v_mul_u32_u24 v12, 6144, v6
    v_lshl_add_u32 v12, v7, 4, v12
    v_mov_b32 v9, 163584
    v_mov_b32_e64 v14, 0
    ds_write_b32 v9, v14
    s_waitcnt lgkmcnt(0)
    s_load_dwordx16 s[64:79], s[0:1], 0
    s_load_dwordx8 s[80:87], s[0:1], 64
    s_load_dwordx2 s[88:89], s[0:1], 96
    s_cmp_ge_u32 s2, 64
    s_cbranch_scc1 L_NOPROD1
    s_cmp_ge_u32 s40, 4
    s_cbranch_scc1 L_PROD1B
    s_and_b32 s52, s2, 3
    s_and_b32 s53, s40, 3
    s_lshl_b32 s53, s53, 6
    s_lshl_b32 s59, s52, 8
    s_add_u32 s53, s53, s59
    buffer_load_ushort v48, v13, s[24:27], s53 offen offset:0
    buffer_load_ushort v49, v13, s[24:27], s53 offen offset:16
    buffer_load_ushort v50, v13, s[24:27], s53 offen offset:32
    buffer_load_ushort v51, v13, s[24:27], s53 offen offset:48
    s_lshr_b32 s52, s2, 2
    s_lshl_b32 s52, s52, 7
    s_mul_i32 s59, s53, 3072
    s_add_u32 s52, s52, s59
    s_nop 0
    buffer_load_dwordx4 v[32:35], v12, s[20:23], s52 offen
    s_add_u32 s52, s52, 49152
    buffer_load_dwordx4 v[36:39], v12, s[20:23], s52 offen
    s_add_u32 s52, s52, 49152
    buffer_load_dwordx4 v[40:43], v12, s[20:23], s52 offen
    s_add_u32 s52, s52, 49152
    buffer_load_dwordx4 v[44:47], v12, s[20:23], s52 offen
L_PROD1B:
    s_barrier
L_NOPROD1:
    s_xor_b32 s53, s91, 0
    s_lshl_b32 s53, s53, 7
    s_add_u32 s53, s53, s51
    s_add_u32 s52, s53, 0
    s_add_u32 m0, s54, 0
    s_nop 0
    buffer_load_dwordx4 v4, s[4:7], s52 offen lds
    s_add_u32 s52, s53, 8192
    s_add_u32 m0, s54, 1024
    s_nop 0
    buffer_load_dwordx4 v5, s[4:7], s52 offen lds
    s_add_u32 s52, s53, 16384
    s_add_u32 m0, s54, 2048
    s_nop 0
    buffer_load_dwordx4 v4, s[4:7], s52 offen lds
    s_add_u32 s52, s53, 24576
    s_add_u32 m0, s54, 3072
    s_nop 0
    buffer_load_dwordx4 v5, s[4:7], s52 offen lds
L_TCH_D:
    v_lshlrev_b32_e64 v2, 4, v1
    s_lshr_b32 s42, s2, 3
    s_cmp_lg_u32 s40, 7
    s_cbranch_scc1 L_NOCPF
    s_getpc_b64 s[60:61]
L_PCREF:
    s_sub_u32 s60, s60, L_PCREF-adaLN_cond__sliding_block__mixer_channel_mlp__prompt_kernel
    s_subb_u32 s61, s61, 0
    s_mul_i32 s52, s42, 1280
    v_lshlrev_b32 v9, 7, v1
    v_add_u32_e64 v9, s52, v9
    v_cmp_gt_u32 vcc, L_CODE_END-adaLN_cond__sliding_block__mixer_channel_mlp__prompt_kernel, v9
    s_nop 0
    s_and_b32 exec_lo, vcc_lo, 0x3ff
    s_mov_b32 exec_hi, 0
    s_cbranch_execz L_NOCPF2
    global_load_dword v23, v9, s[60:61]
L_NOCPF2:
    s_mov_b64 exec, -1
L_NOCPF:
    s_waitcnt lgkmcnt(0)
    s_load_dword s100, s[88:89], 0
    s_lshr_b32 s44, s42, 2
    s_xor_b32 s44, s44, 4
    s_bfe_u32 s45, s42, 0x10001
    s_and_b32 s48, s42, 3
    s_lshr_b32 s49, s42, 2
    v_and_b32 v9, 1, v8
    v_lshlrev_b32 v9, 2, v9
    v_xor_b32 v9, v9, v7
    v_lshlrev_b32_e64 v9, 4, v9
    v_mul_u32_u24 v28, 3072, v6
    v_add_u32 v28, v28, v9
    v_lshrrev_b32 v9, 2, v1
    v_mul_u32_u24 v11, 3072, v9
    v_and_b32_e64 v9, 3, v1
    v_lshl_add_u32 v11, v9, 4, v11
    s_lshr_b32 s52, s40, 2
    s_and_b32 s58, s40, 3
    s_mul_i32 s55, s52, 786432
    s_mul_i32 s59, s58, 24576
    s_add_u32 s55, s55, s59
    s_lshl_b32 s59, s44, 7
    s_add_u32 s55, s55, s59
    s_lshl_b32 s59, s45, 10
    s_add_u32 s55, s55, s59
    s_add_u32 s55, s55, 1024
    s_mul_i32 s56, s52, 786432
    s_mul_i32 s59, s58, 49152
    s_add_u32 s56, s56, s59
    s_lshl_b32 s59, s44, 7
    s_add_u32 s56, s56, s59
    s_lshl_b32 s59, s45, 6
    s_add_u32 s56, s56, s59
    s_mov_b32 s8, s66
    s_mov_b32 s9, s67
    s_mov_b32 s10, 1572864
    s_mov_b32 s11, 0x20000
    s_mov_b32 s12, s88
    s_mov_b32 s13, s89
    s_mov_b32 s14, 28311552
    s_mov_b32 s15, 0x20000
    s_mov_b32 s28, s74
    s_mov_b32 s29, s75
    s_mov_b32 s30, 3584
    s_mov_b32 s31, 0x20000
    s_mov_b32 s32, s78
    s_mov_b32 s33, s79
    s_mov_b32 s34, 1024
    s_mov_b32 s35, 0x20000
    s_mov_b32 s36, s84
    s_mov_b32 s37, s85
    s_mov_b32 s38, 2097152
    s_mov_b32 s39, 0x20000
    s_mov_b32 s92, s68
    s_mov_b32 s93, s69
    s_mov_b32 s94, 524288
    s_mov_b32 s95, 0x20000
    s_lshl_b32 s58, s2, 3
    s_add_u32 s58, s58, s40
    s_mov_b32 s19, 0x20000
    s_mov_b32 s18, 1835008
    s_cmp_lt_u32 s58, 896
    s_cselect_b64 s[16:17], s[72:73], s[76:77]
    s_cbranch_scc1 L_RL_W1
    s_sub_u32 s58, s2, 112
    s_mul_i32 s52, s58, 4682
    s_lshr_b32 s52, s52, 16
    s_mul_i32 s57, s52, 14
    s_sub_u32 s57, s58, s57
    s_lshl_b32 s57, s57, 3
    s_add_u32 s57, s57, s40
    s_mul_i32 s98, s52, 229376
    s_lshl_b32 s59, s57, 11
    s_add_u32 s98, s98, s59
    s_add_u32 s98, s98, 4194304
    s_lshr_b32 s58, s57, 2
    s_lshl_b32 s53, s58, 16
    s_lshl_b32 s59, s52, 7
    s_add_u32 s53, s53, s59
    s_and_b32 s58, s57, 1
    s_lshl_b32 s58, s58, 15
    s_add_u32 s53, s53, s58
    s_and_b32 s58, s57, 2
    s_lshl_b32 s58, s58, 9
    s_add_u32 s53, s53, s58
    s_mov_b32 s96, 2048
    s_mov_b32 s97, 16384
    s_mov_b32 s57, 8192
    s_mov_b32 s99, 1024
    s_branch L_RL_DONE
L_RL_W1:
    s_and_b32 s57, s58, 31
    s_lshr_b32 s52, s58, 5
    s_mul_i32 s53, s57, 57344
    s_lshl_b32 s59, s52, 7
    s_add_u32 s53, s53, s59
    s_lshl_b32 s98, s52, 16
    s_lshl_b32 s59, s57, 10
    s_add_u32 s98, s98, s59
    s_add_u32 s98, s98, 2097152
    s_mov_b32 s96, 3584
    s_mov_b32 s97, 14336
    s_mov_b32 s57, 28672
    s_mov_b32 s99, 32768
L_RL_DONE:
    v_lshrrev_b32 v20, 5, v1
    v_mul_lo_u32 v30, s57, v20
    v_and_b32_e64 v9, 31, v1
    v_lshl_add_u32 v30, v9, 2, v30
    s_cmp_ge_u32 s2, 224
    s_cselect_b32 s53, 0x40000000, s53
    v_add_u32 v30, s53, v30
    v_mul_lo_u32 v31, s57, v6
    v_bfe_u32 v21, v1, 2, 1
    v_mul_lo_u32 v21, s97, v21
    v_and_b32_e64 v22, 3, v1
    v_mul_lo_u32 v22, s96, v22
    v_add3_u32 v31, v31, v21, v22
    v_add_u32 v31, s53, v31
    v_and_b32 v21, 15, v1
    s_mul_i32 s52, s42, 49152
    s_mul_i32 s59, s40, 6144
    s_add_u32 s52, s52, s59
    v_bfe_u32 v22, v1, 3, 1
    v_mul_u32_u24 v22, 3072, v22
    v_lshl_add_u32 v22, v7, 7, v22
    v_add_u32 v22, s52, v22
    s_mov_b32 exec_lo, 0xffffffff
    s_mov_b32 exec_hi, 0xffffffff
    v_add_co_u32 v24, vcc, s8, v22
    v_mov_b32 v25, s9
    s_nop 0
    v_addc_co_u32 v25, vcc, 0, v25, vcc
    s_mov_b64 exec, -1
    s_lshl_b32 s52, s42, 14
    s_lshl_b32 s59, s40, 11
    s_add_u32 s52, s52, s59
    v_lshlrev_b32 v22, 7, v21
    v_add_u32_e64 v22, s52, v22
    s_mov_b32 exec_lo, 0x0
    s_mov_b32 exec_hi, 0xffff
    v_add_co_u32 v24, vcc, s92, v22
    v_mov_b32 v25, s93
    s_nop 0
    v_addc_co_u32_e64 v25, vcc, 0, v25, vcc
    s_mov_b64 exec, -1
    s_and_b32 s52, s41, 3
    s_lshr_b32 s53, s41, 2
    s_mul_i32 s52, s52, 786432
    s_mul_i32 s59, s42, 24576
    s_add_u32 s52, s52, s59
    s_mul_i32 s59, s46, 6144
    s_add_u32 s52, s52, s59
    s_lshl_b32 s59, s53, 7
    s_add_u32 s52, s52, s59
    s_lshl_b32 s59, s47, 11
    s_add_u32 s52, s52, s59
    s_add_u32 s52, s52, 2048
    v_lshlrev_b32 v22, 8, v7
    v_add_u32 v22, s52, v22
    s_mov_b32 exec_lo, 0xff0000
    s_mov_b32 exec_hi, 0x0
    v_add_co_u32 v24, vcc, s20, v22
    v_mov_b32 v25, s21
    s_nop 0
    v_addc_co_u32 v25, vcc, 0, v25, vcc
    s_mov_b64 exec, -1
    s_cmp_ge_u32 s2, 224
    s_cbranch_scc1 L_NOTR
    s_mov_b32 exec_lo, 0xffff
    s_mov_b32 exec_hi, 0x0
    v_add_co_u32 v24, vcc, s16, v31
    v_mov_b32 v25, s17
    s_nop 0
    v_addc_co_u32 v25, vcc, 0, v25, vcc
    s_mov_b64 exec, -1
L_NOTR:
    s_lshl_b32 s52, s41, 16
    s_lshl_b32 s59, s42, 11
    s_add_u32 s52, s52, s59
    s_lshl_b32 s59, s40, 8
    s_add_u32 s52, s52, s59
    s_add_u32 s52, s52, 524288
    v_lshlrev_b32 v21, 7, v1
    v_add_u32 v22, s52, v21
    s_mov_b32 exec_lo, 0x3ff
    s_mov_b32 exec_hi, 0x0
    v_add_co_u32 v26, vcc, s12, v22
    v_mov_b32 v27, s13
    s_nop 0
    v_addc_co_u32_e64 v27, vcc, 0, v27, vcc
    s_mov_b64 exec, -1
    s_lshl_b32 s52, s41, 12
    s_mul_i32 s59, s40, 384
    s_add_u32 s52, s52, s59
    s_add_u32 s52, s52, 458496
    v_add_u32 v22, s52, v21
    s_mov_b32 exec_lo, 0x1c
    s_mov_b32 exec_hi, 0x0
    v_add_co_u32 v26, vcc, s12, v22
    v_mov_b32 v27, s13
    s_nop 0
    v_addc_co_u32_e64 v27, vcc, 0, v27, vcc
    s_mov_b64 exec, -1
    s_mul_i32 s52, s40, 448
    s_add_u32 s52, s52, 4294966656
    v_add_u32_e64 v22, s52, v21
    s_mov_b32 exec_lo, 0x1e0
    s_mov_b32 exec_hi, 0x0
    v_add_co_u32 v26, vcc, s28, v22
    v_mov_b32 v27, s29
    s_nop 0
    v_addc_co_u32_e64 v27, vcc, 0, v27, vcc
    s_mov_b64 exec, -1
    s_lshl_b32 s52, s40, 7
    s_add_u32 s52, s52, 4294966144
    v_add_u32_e64 v22, s52, v21
    s_mov_b32 exec_lo, 0x200
    s_mov_b32 exec_hi, 0x0
    v_add_co_u32 v26, vcc, s32, v22
    v_mov_b32 v27, s33
    s_nop 0
    v_addc_co_u32_e64 v27, vcc, 0, v27, vcc
    s_mov_b64 exec, -1
    s_waitcnt lgkmcnt(0)
    s_mul_i32 s50, s100, 0x9E3779B1
    s_add_u32 s50, s50, 0x7F4A7C15
    s_and_b32 s50, s50, 0xfffffff0
    s_getreg_b32 s3, hwreg(HW_REG_XCC_ID)
    s_and_b32 s3, s3, 15
    s_or_b32 s3, s3, s50
    v_lshrrev_b32 v21, 1, v9
    v_and_b32 v21, 7, v21
    v_xor_b32 v21, v21, v20
    v_lshlrev_b32 v21, 4, v21
    v_lshl_add_u32 v12, v9, 7, v21
    v_add_u32 v12, s54, v12
    v_xor_b32 v13, 32, v12
    v_xor_b32_e64 v14, 64, v12
    v_xor_b32 v15, 96, v12
    v_mov_b32 v16, 0x3f803f80
    v_mov_b32 v17, 0x3f803f80
    v_mov_b32 v18, 0x3f803f80
    v_mov_b32 v19, 0x3f803f80
    v_and_b32_e64 v21, 1, v1
    v_cmp_ne_u32 s[64:65], 0, v21
    v_and_b32_e64 v21, 2, v1
    v_cmp_ne_u32 s[66:67], 0, v21
    v_and_b32_e64 v21, 8, v1
    v_cmp_ne_u32 s[68:69], 0, v21
    v_and_b32_e64 v21, 16, v1
    v_cmp_ne_u32 s[70:71], 0, v21
    v_bfe_u32 v21, v1, 2, 1
    v_cmp_eq_u32 s[72:73], v21, v20
    s_cmp_ge_u32 s2, 64
    s_cbranch_scc1 L_NOPROD2
    s_cmp_ge_u32 s40, 4
    s_cbranch_scc1 L_NOPROD2
    s_waitcnt vmcnt(8)
    v_lshlrev_b32 v48, 16, v48
    v_lshlrev_b32 v49, 16, v49
    v_lshlrev_b32 v50, 16, v50
    v_lshlrev_b32_e64 v51, 16, v51
    v_mul_f32 v52, 0xbfb8aa3b, v48
    v_mul_f32 v53, 0xbfb8aa3b, v49
    v_mul_f32 v54, 0xbfb8aa3b, v50
    v_mul_f32 v55, 0xbfb8aa3b, v51
    v_exp_f32 v52, v52
    v_exp_f32 v53, v53
    v_exp_f32 v54, v54
    v_exp_f32 v55, v55
    v_add_f32 v52, 1.0, v52
    v_add_f32 v53, 1.0, v53
    v_add_f32 v54, 1.0, v54
    v_add_f32 v55, 1.0, v55
    v_rcp_f32 v52, v52
    v_rcp_f32 v53, v53
    v_rcp_f32 v54, v54
    v_rcp_f32 v55, v55
    v_mul_f32 v48, v48, v52
    v_mul_f32 v49, v49, v53
    v_mul_f32 v50, v50, v54
    v_mul_f32 v51, v51, v55
    v_cvt_pk_bf16_f32 v48, v48, v48
    v_cvt_pk_bf16_f32 v49, v49, v49
    v_cvt_pk_bf16_f32 v50, v50, v50
    v_cvt_pk_bf16_f32 v51, v51, v51
    v_and_b32 v48, 0xffff0000, v48
    v_and_b32 v49, 0xffff0000, v49
    v_and_b32 v50, 0xffff0000, v50
    v_and_b32 v51, 0xffff0000, v51
    v_and_b32 v68, 7, v1
    v_lshlrev_b32 v68, 5, v68
    v_lshl_add_u32 v68, v8, 3, v68
    s_and_b32 s52, s40, 3
    s_lshl_b32 s52, s52, 8
    s_add_u32 s52, s52, 162560
    v_add_u32_e64 v68, s52, v68
    v_mov_b32 v69, 163584
    v_mov_b32 v70, 1
    s_waitcnt vmcnt(7)
    v_lshlrev_b32_e64 v52, 16, v32
    v_and_b32 v53, 0xffff0000, v32
    v_lshlrev_b32_e64 v54, 16, v33
    v_and_b32 v55, 0xffff0000, v33
    v_lshlrev_b32_e64 v56, 16, v34
    v_and_b32 v57, 0xffff0000, v34
    v_lshlrev_b32_e64 v58, 16, v35
    v_and_b32 v59, 0xffff0000, v35
    v_mul_f32 v60, v52, v48
    v_mul_f32 v61, v53, v48
    v_mul_f32 v62, v54, v48
    v_mul_f32 v63, v55, v48
    v_mul_f32 v64, v56, v48
    v_mul_f32 v65, v57, v48
    v_mul_f32 v66, v58, v48
    v_mul_f32 v67, v59, v48
    s_waitcnt vmcnt(6)
    v_lshlrev_b32 v52, 16, v36
    v_and_b32 v53, 0xffff0000, v36
    v_lshlrev_b32_e64 v54, 16, v37
    v_and_b32 v55, 0xffff0000, v37
    v_lshlrev_b32_e64 v56, 16, v38
    v_and_b32 v57, 0xffff0000, v38
    v_lshlrev_b32_e64 v58, 16, v39
    v_and_b32 v59, 0xffff0000, v39
    v_fmac_f32 v60, v52, v49
    v_fmac_f32 v61, v53, v49
    v_fmac_f32 v62, v54, v49
    v_fmac_f32 v63, v55, v49
    v_fmac_f32 v64, v56, v49
    v_fmac_f32 v65, v57, v49
    v_fmac_f32 v66, v58, v49
    v_fmac_f32 v67, v59, v49
    s_waitcnt vmcnt(5)
    v_lshlrev_b32 v52, 16, v40
    v_and_b32 v53, 0xffff0000, v40
    v_lshlrev_b32_e64 v54, 16, v41
    v_and_b32 v55, 0xffff0000, v41
    v_lshlrev_b32_e64 v56, 16, v42
    v_and_b32 v57, 0xffff0000, v42
    v_lshlrev_b32_e64 v58, 16, v43
    v_and_b32 v59, 0xffff0000, v43
    v_fmac_f32 v60, v52, v50
    v_fmac_f32 v61, v53, v50
    v_fmac_f32 v62, v54, v50
    v_fmac_f32 v63, v55, v50
    v_fmac_f32 v64, v56, v50
    v_fmac_f32 v65, v57, v50
    v_fmac_f32 v66, v58, v50
    v_fmac_f32 v67, v59, v50
    s_waitcnt vmcnt(4)
    v_lshlrev_b32 v52, 16, v44
    v_and_b32 v53, 0xffff0000, v44
    v_lshlrev_b32_e64 v54, 16, v45
    v_and_b32 v55, 0xffff0000, v45
    v_lshlrev_b32_e64 v56, 16, v46
    v_and_b32 v57, 0xffff0000, v46
    v_lshlrev_b32_e64 v58, 16, v47
    v_and_b32 v59, 0xffff0000, v47
    v_fmac_f32 v60, v52, v51
    v_fmac_f32 v61, v53, v51
    v_fmac_f32 v62, v54, v51
    v_fmac_f32 v63, v55, v51
    v_fmac_f32 v64, v56, v51
    v_fmac_f32 v65, v57, v51
    v_fmac_f32 v66, v58, v51
    v_fmac_f32 v67, v59, v51
    v_permlane32_swap_b32 v60, v64
    v_permlane32_swap_b32 v61, v65
    v_permlane32_swap_b32 v62, v66
    v_permlane32_swap_b32 v63, v67
    v_add_f32 v60, v60, v64
    v_add_f32 v61, v61, v65
    v_add_f32 v62, v62, v66
    v_add_f32 v63, v63, v67
    s_nop 0
    v_permlane16_swap_b32 v60, v62
    v_permlane16_swap_b32 v61, v63
    v_add_f32 v60, v60, v62
    v_add_f32 v61, v61, v63
    s_nop 0
    v_add_f32_dpp v60, v60, v60 row_ror:8 row_mask:0xf bank_mask:0xf
    v_add_f32_dpp v61, v61, v61 row_ror:8 row_mask:0xf bank_mask:0xf
    ds_write_b64 v68, v[60:61]
    s_mov_b64 exec, 1
    ds_add_rtn_u32 v70, v69, v70
    s_mov_b64 exec, -1
    v_add_u32 v69, 162560, v2
    v_mov_b32 v68, 0xff
    s_waitcnt lgkmcnt(0)
    v_readfirstlane_b32 s52, v70
    s_nop 0
    s_cmp_lg_u32 s52, 3
    s_cbranch_scc1 L_NOPROD2
    s_mov_b64 exec, 0xffff
    ds_read_b128 v[32:35], v69 offset:0
    ds_read_b128 v[36:39], v69 offset:256
    ds_read_b128 v[40:43], v69 offset:512
    ds_read_b128 v[44:47], v69 offset:768
    s_lshl_b32 s52, s2, 8
    s_add_u32 s52, s52, 65536
    s_waitcnt lgkmcnt(0)
    s_nop 0
    v_pk_add_f32 v[32:33], v[32:33], v[36:37]
    v_pk_add_f32 v[40:41], v[40:41], v[44:45]
    v_pk_add_f32 v[34:35], v[34:35], v[38:39]
    v_pk_add_f32 v[42:43], v[42:43], v[46:47]
    v_pk_add_f32 v[32:33], v[32:33], v[40:41]
    v_pk_add_f32 v[34:35], v[34:35], v[42:43]
    s_lshr_b32 s53, s50, 0
    v_add_u32 v32, 0x80, v32
    v_bfi_b32 v32, v68, s53, v32
    s_lshr_b32 s53, s50, 8
    v_add_u32 v33, 0x80, v33
    v_bfi_b32 v33, v68, s53, v33
    s_lshr_b32 s53, s50, 16
    v_add_u32 v34, 0x80, v34
    v_bfi_b32 v34, v68, s53, v34
    s_lshr_b32 s53, s50, 24
    v_add_u32 v35, 0x80, v35
    v_bfi_b32 v35, v68, s53, v35
    buffer_store_dwordx4 v[32:35], v2, s[12:15], s52 offen sc1
    s_mov_b64 exec, -1
L_NOPROD2:
    s_xor_b32 s53, s91, 1
    s_lshl_b32 s53, s53, 7
    s_add_u32 s53, s53, s51
    s_add_u32 s52, s53, 0
    s_add_u32 m0, s54, 4096
    s_nop 0
    buffer_load_dwordx4 v4, s[4:7], s52 offen lds
    s_add_u32 s52, s53, 8192
    s_add_u32 m0, s54, 5120
    s_nop 0
    buffer_load_dwordx4 v5, s[4:7], s52 offen lds
    s_add_u32 s52, s53, 16384
    s_add_u32 m0, s54, 6144
    s_nop 0
    buffer_load_dwordx4 v4, s[4:7], s52 offen lds
    s_add_u32 s52, s53, 24576
    s_add_u32 m0, s54, 7168
    s_nop 0
    buffer_load_dwordx4 v5, s[4:7], s52 offen lds
    s_xor_b32 s53, s91, 2
    s_lshl_b32 s53, s53, 7
    s_add_u32 s53, s53, s51
    s_add_u32 s52, s53, 0
    s_add_u32 m0, s54, 8192
    s_nop 0
    buffer_load_dwordx4 v4, s[4:7], s52 offen lds
    s_add_u32 s52, s53, 8192
    s_add_u32 m0, s54, 9216
    s_nop 0
    buffer_load_dwordx4 v5, s[4:7], s52 offen lds
    s_add_u32 s52, s53, 16384
    s_add_u32 m0, s54, 10240
    s_nop 0
    buffer_load_dwordx4 v4, s[4:7], s52 offen lds
    s_add_u32 s52, s53, 24576
    s_add_u32 m0, s54, 11264
    s_nop 0
    buffer_load_dwordx4 v5, s[4:7], s52 offen lds
    s_waitcnt vmcnt(8)
    ds_read_b128 v[96:99], v12 offset:0
    ds_read_b128 v[100:103], v13 offset:0
    ds_read_b128 v[104:107], v14 offset:0
    ds_read_b128 v[108:111], v15 offset:0
    s_waitcnt lgkmcnt(3)
    v_mfma_f32_32x32x16_bf16 v[64:79], v[16:19], v[96:99], 0
    v_lshlrev_b32 v128, 16, v96
    v_and_b32 v129, 0xffff0000, v96
    v_lshlrev_b32_e64 v130, 16, v97
    v_and_b32 v131, 0xffff0000, v97
    v_mfma_f32_32x32x16_bf16 v[80:95], v[96:99], v[96:99], 0
    v_lshlrev_b32_e64 v132, 16, v98
    v_and_b32 v133, 0xffff0000, v98
    v_lshlrev_b32_e64 v134, 16, v99
    v_and_b32 v135, 0xffff0000, v99
    s_waitcnt lgkmcnt(2)
    v_mfma_f32_32x32x16_bf16 v[64:79], v[16:19], v[100:103], v[64:79]
    v_lshlrev_b32 v136, 16, v100
    v_and_b32 v137, 0xffff0000, v100
    v_lshlrev_b32_e64 v138, 16, v101
    v_and_b32 v139, 0xffff0000, v101
    v_mfma_f32_32x32x16_bf16 v[80:95], v[100:103], v[100:103], v[80:95]
    v_lshlrev_b32_e64 v140, 16, v102
    v_and_b32 v141, 0xffff0000, v102
    v_lshlrev_b32_e64 v142, 16, v103
    v_and_b32 v143, 0xffff0000, v103
    s_waitcnt lgkmcnt(1)
    v_mfma_f32_32x32x16_bf16 v[64:79], v[16:19], v[104:107], v[64:79]
    v_lshlrev_b32 v144, 16, v104
    v_and_b32 v145, 0xffff0000, v104
    v_lshlrev_b32_e64 v146, 16, v105
    v_and_b32 v147, 0xffff0000, v105
    v_mfma_f32_32x32x16_bf16 v[80:95], v[104:107], v[104:107], v[80:95]
    v_lshlrev_b32_e64 v148, 16, v106
    v_and_b32 v149, 0xffff0000, v106
    v_lshlrev_b32_e64 v150, 16, v107
    v_and_b32 v151, 0xffff0000, v107
    s_waitcnt lgkmcnt(0)
    v_mfma_f32_32x32x16_bf16 v[64:79], v[16:19], v[108:111], v[64:79]
    v_lshlrev_b32 v152, 16, v108
    v_and_b32 v153, 0xffff0000, v108
    v_lshlrev_b32_e64 v154, 16, v109
    v_and_b32 v155, 0xffff0000, v109
    v_mfma_f32_32x32x16_bf16 v[80:95], v[108:111], v[108:111], v[80:95]
    v_lshlrev_b32_e64 v156, 16, v110
    v_and_b32 v157, 0xffff0000, v110
    v_lshlrev_b32_e64 v158, 16, v111
    v_and_b32 v159, 0xffff0000, v111
    s_xor_b32 s53, s91, 3
    s_lshl_b32 s53, s53, 7
    s_add_u32 s53, s53, s51
    s_add_u32 s52, s53, 0
    s_add_u32 m0, s54, 12288
    s_nop 0
    buffer_load_dwordx4 v4, s[4:7], s52 offen lds
    s_add_u32 s52, s53, 8192
    s_add_u32 m0, s54, 13312
    s_nop 0
    buffer_load_dwordx4 v5, s[4:7], s52 offen lds
    s_add_u32 s52, s53, 16384
    s_add_u32 m0, s54, 14336
    s_nop 0
    buffer_load_dwordx4 v4, s[4:7], s52 offen lds
    s_add_u32 s52, s53, 24576
    s_add_u32 m0, s54, 15360
    s_nop 0
    buffer_load_dwordx4 v5, s[4:7], s52 offen lds
    s_mul_i32 s53, s40, 3072
    s_xor_b32 s52, s91, 0
    s_mul_i32 s52, s52, 196608
    s_add_u32 s52, s52, s55
    s_add_u32 m0, s53, 131072
    s_nop 0
    buffer_load_dwordx4 v28, s[8:11], s52 offen lds
    s_xor_b32 s52, s91, 0
    s_mul_i32 s52, s52, 196608
    s_add_u32 s52, s52, s55
    s_add_u32 s52, s52, 98304
    s_add_u32 m0, s53, 132096
    s_nop 0
    buffer_load_dwordx4 v28, s[8:11], s52 offen lds
    s_xor_b32 s52, s91, 1
    s_mul_i32 s52, s52, 196608
    s_add_u32 s52, s52, s55
    s_add_u32 m0, s53, 133120
    s_nop 0
    buffer_load_dwordx4 v28, s[8:11], s52 offen lds
    s_waitcnt vmcnt(11)
    ds_read_b128 v[112:115], v12 offset:4096
    ds_read_b128 v[116:119], v13 offset:4096
    ds_read_b128 v[120:123], v14 offset:4096
    ds_read_b128 v[124:127], v15 offset:4096
    s_waitcnt lgkmcnt(3)
    v_mfma_f32_32x32x16_bf16 v[64:79], v[16:19], v[112:115], v[64:79]
    v_lshlrev_b32 v160, 16, v112
    v_and_b32 v161, 0xffff0000, v112
    v_lshlrev_b32_e64 v162, 16, v113
    v_and_b32 v163, 0xffff0000, v113
    v_mfma_f32_32x32x16_bf16 v[80:95], v[112:115], v[112:115], v[80:95]
    v_lshlrev_b32_e64 v164, 16, v114
    v_and_b32 v165, 0xffff0000, v114
    v_lshlrev_b32_e64 v166, 16, v115
    v_and_b32 v167, 0xffff0000, v115
    s_waitcnt lgkmcnt(2)
    v_mfma_f32_32x32x16_bf16 v[64:79], v[16:19], v[116:119], v[64:79]
    v_lshlrev_b32 v168, 16, v116
    v_and_b32 v169, 0xffff0000, v116
    v_lshlrev_b32_e64 v170, 16, v117
    v_and_b32 v171, 0xffff0000, v117
    v_mfma_f32_32x32x16_bf16 v[80:95], v[116:119], v[116:119], v[80:95]
    v_lshlrev_b32_e64 v172, 16, v118
    v_and_b32 v173, 0xffff0000, v118
    v_lshlrev_b32_e64 v174, 16, v119
    v_and_b32 v175, 0xffff0000, v119
    s_waitcnt lgkmcnt(1)
    v_mfma_f32_32x32x16_bf16 v[64:79], v[16:19], v[120:123], v[64:79]
    v_lshlrev_b32 v176, 16, v120
    v_and_b32 v177, 0xffff0000, v120
    v_lshlrev_b32_e64 v178, 16, v121
    v_and_b32 v179, 0xffff0000, v121
    v_mfma_f32_32x32x16_bf16 v[80:95], v[120:123], v[120:123], v[80:95]
    v_lshlrev_b32_e64 v180, 16, v122
    v_and_b32 v181, 0xffff0000, v122
    v_lshlrev_b32_e64 v182, 16, v123
    v_and_b32 v183, 0xffff0000, v123
    s_waitcnt lgkmcnt(0)
    v_mfma_f32_32x32x16_bf16 v[64:79], v[16:19], v[124:127], v[64:79]
    v_lshlrev_b32 v184, 16, v124
    v_and_b32 v185, 0xffff0000, v124
    v_lshlrev_b32_e64 v186, 16, v125
    v_and_b32 v187, 0xffff0000, v125
    v_mfma_f32_32x32x16_bf16 v[80:95], v[124:127], v[124:127], v[80:95]
    v_lshlrev_b32_e64 v188, 16, v126
    v_and_b32 v189, 0xffff0000, v126
    v_lshlrev_b32_e64 v190, 16, v127
    v_and_b32 v191, 0xffff0000, v127
    s_xor_b32 s52, s91, 1
    s_mul_i32 s52, s52, 196608
    s_add_u32 s52, s52, s55
    s_add_u32 s52, s52, 98304
    s_add_u32 m0, s54, 0
    s_nop 0
    buffer_load_dwordx4 v28, s[8:11], s52 offen lds
    s_xor_b32 s52, s91, 2
    s_mul_i32 s52, s52, 196608
    s_add_u32 s52, s52, s55
    s_add_u32 m0, s54, 1024
    s_nop 0
    buffer_load_dwordx4 v28, s[8:11], s52 offen lds
    s_xor_b32 s52, s91, 2
    s_mul_i32 s52, s52, 196608
    s_add_u32 s52, s52, s55
    s_add_u32 s52, s52, 98304
    s_add_u32 m0, s54, 2048
    s_nop 0
    buffer_load_dwordx4 v28, s[8:11], s52 offen lds
    s_xor_b32 s52, s91, 3
    s_mul_i32 s52, s52, 196608
    s_add_u32 s52, s52, s55
    s_add_u32 m0, s54, 3072
    s_nop 0
    buffer_load_dwordx4 v28, s[8:11], s52 offen lds
    s_xor_b32 s52, s91, 3
    s_mul_i32 s52, s52, 196608
    s_add_u32 s52, s52, s55
    s_add_u32 s52, s52, 98304
    s_add_u32 m0, s54, 4096
    s_nop 0
    buffer_load_dwordx4 v28, s[8:11], s52 offen lds
    s_waitcnt vmcnt(12)
    ds_read_b128 v[96:99], v12 offset:8192
    ds_read_b128 v[100:103], v13 offset:8192
    ds_read_b128 v[104:107], v14 offset:8192
    ds_read_b128 v[108:111], v15 offset:8192
    s_waitcnt lgkmcnt(3)
    v_mfma_f32_32x32x16_bf16 v[64:79], v[16:19], v[96:99], v[64:79]
    v_lshlrev_b32_e64 v192, 16, v96
    v_and_b32 v193, 0xffff0000, v96
    v_lshlrev_b32_e64 v194, 16, v97
    v_and_b32 v195, 0xffff0000, v97
    v_mfma_f32_32x32x16_bf16 v[80:95], v[96:99], v[96:99], v[80:95]
    v_lshlrev_b32_e64 v196, 16, v98
    v_and_b32 v197, 0xffff0000, v98
    v_lshlrev_b32_e64 v198, 16, v99
    v_and_b32 v199, 0xffff0000, v99
    s_waitcnt lgkmcnt(2)
    v_mfma_f32_32x32x16_bf16 v[64:79], v[16:19], v[100:103], v[64:79]
    v_lshlrev_b32 v200, 16, v100
    v_and_b32 v201, 0xffff0000, v100
    v_lshlrev_b32_e64 v202, 16, v101
    v_and_b32 v203, 0xffff0000, v101
    v_mfma_f32_32x32x16_bf16 v[80:95], v[100:103], v[100:103], v[80:95]
    v_lshlrev_b32_e64 v204, 16, v102
    v_and_b32 v205, 0xffff0000, v102
    v_lshlrev_b32_e64 v206, 16, v103
    v_and_b32 v207, 0xffff0000, v103
    s_waitcnt lgkmcnt(1)
    v_mfma_f32_32x32x16_bf16 v[64:79], v[16:19], v[104:107], v[64:79]
    v_lshlrev_b32 v208, 16, v104
    v_and_b32 v209, 0xffff0000, v104
    v_lshlrev_b32_e64 v210, 16, v105
    v_and_b32 v211, 0xffff0000, v105
    v_mfma_f32_32x32x16_bf16 v[80:95], v[104:107], v[104:107], v[80:95]
    v_lshlrev_b32_e64 v212, 16, v106
    v_and_b32 v213, 0xffff0000, v106
    v_lshlrev_b32_e64 v214, 16, v107
    v_and_b32 v215, 0xffff0000, v107
    s_waitcnt lgkmcnt(0)
    v_mfma_f32_32x32x16_bf16 v[64:79], v[16:19], v[108:111], v[64:79]
    v_lshlrev_b32 v216, 16, v108
    v_and_b32 v217, 0xffff0000, v108
    v_lshlrev_b32_e64 v218, 16, v109
    v_and_b32 v219, 0xffff0000, v109
    v_mfma_f32_32x32x16_bf16 v[80:95], v[108:111], v[108:111], v[80:95]
    v_lshlrev_b32_e64 v220, 16, v110
    v_and_b32 v221, 0xffff0000, v110
    v_lshlrev_b32_e64 v222, 16, v111
    v_and_b32 v223, 0xffff0000, v111
    s_waitcnt vmcnt(8)
    ds_read_b128 v[112:115], v12 offset:12288
    ds_read_b128 v[116:119], v13 offset:12288
    ds_read_b128 v[120:123], v14 offset:12288
    ds_read_b128 v[124:127], v15 offset:12288
    s_waitcnt lgkmcnt(3)
    v_mfma_f32_32x32x16_bf16 v[64:79], v[16:19], v[112:115], v[64:79]
    v_lshlrev_b32_e64 v224, 16, v112
    v_and_b32 v225, 0xffff0000, v112
    v_lshlrev_b32_e64 v226, 16, v113
    v_and_b32 v227, 0xffff0000, v113
    v_mfma_f32_32x32x16_bf16 v[80:95], v[112:115], v[112:115], v[80:95]
    v_lshlrev_b32_e64 v228, 16, v114
    v_and_b32 v229, 0xffff0000, v114
    v_lshlrev_b32_e64 v230, 16, v115
    v_and_b32 v231, 0xffff0000, v115
    s_waitcnt lgkmcnt(2)
    v_mfma_f32_32x32x16_bf16 v[64:79], v[16:19], v[116:119], v[64:79]
    v_lshlrev_b32 v232, 16, v116
    v_and_b32 v233, 0xffff0000, v116
    v_lshlrev_b32_e64 v234, 16, v117
    v_and_b32 v235, 0xffff0000, v117
    v_mfma_f32_32x32x16_bf16 v[80:95], v[116:119], v[116:119], v[80:95]
    v_lshlrev_b32_e64 v236, 16, v118
    v_and_b32 v237, 0xffff0000, v118
    v_lshlrev_b32_e64 v238, 16, v119
    v_and_b32 v239, 0xffff0000, v119
    s_waitcnt lgkmcnt(1)
    v_mfma_f32_32x32x16_bf16 v[64:79], v[16:19], v[120:123], v[64:79]
    v_lshlrev_b32 v240, 16, v120
    v_and_b32 v241, 0xffff0000, v120
    v_lshlrev_b32_e64 v242, 16, v121
    v_and_b32 v243, 0xffff0000, v121
    v_mfma_f32_32x32x16_bf16 v[80:95], v[120:123], v[120:123], v[80:95]
    v_lshlrev_b32_e64 v244, 16, v122
    v_and_b32 v245, 0xffff0000, v122
    v_lshlrev_b32_e64 v246, 16, v123
    v_and_b32 v247, 0xffff0000, v123
    s_waitcnt lgkmcnt(0)
    v_mfma_f32_32x32x16_bf16 v[64:79], v[16:19], v[124:127], v[64:79]
    v_lshlrev_b32 v248, 16, v124
    v_and_b32 v249, 0xffff0000, v124
    v_lshlrev_b32_e64 v250, 16, v125
    v_and_b32 v251, 0xffff0000, v125
    v_mfma_f32_32x32x16_bf16 v[80:95], v[124:127], v[124:127], v[80:95]
    v_lshlrev_b32_e64 v252, 16, v126
    v_and_b32 v253, 0xffff0000, v126
    v_lshlrev_b32_e64 v254, 16, v127
    v_and_b32 v255, 0xffff0000, v127
    s_lshl_b32 s52, s46, 9
    s_add_u32 s52, s52, 159744
    v_lshlrev_b32 v17, 4, v9
    v_add_u32 v17, s52, v17
    s_lshl_b32 s52, s47, 3
    v_cndmask_b32 v18, 0, 4, s[72:73]
    v_add3_u32 v18, v18, v17, s52
    s_nop 0
    s_nop 0
    v_cndmask_b32 v80, v80, v81, s[64:65]
    v_cndmask_b32 v81, v82, v83, s[64:65]
    v_cndmask_b32 v82, v84, v85, s[64:65]
    v_cndmask_b32 v83, v86, v87, s[64:65]
    v_cndmask_b32 v84, v88, v89, s[64:65]
    v_cndmask_b32 v85, v90, v91, s[64:65]
    v_cndmask_b32 v86, v92, v93, s[64:65]
    v_cndmask_b32 v87, v94, v95, s[64:65]
    v_cndmask_b32 v80, v80, v81, s[66:67]
    v_cndmask_b32 v81, v82, v83, s[66:67]
    v_cndmask_b32 v82, v84, v85, s[66:67]
    v_cndmask_b32 v83, v86, v87, s[66:67]
    v_cndmask_b32 v80, v80, v81, s[68:69]
    v_cndmask_b32 v81, v82, v83, s[68:69]
    v_cndmask_b32 v80, v80, v81, s[70:71]
    v_cndmask_b32 v16, v64, v80, s[72:73]
    ds_write_b32 v18, v16
    v_bfe_u32 v9, v1, 2, 2
    v_and_b32 v21, 3, v1
    v_and_b32 v22, 1, v8
    v_lshlrev_b32_e64 v12, 7, v9
    v_lshl_add_u32 v12, v21, 3, v12
    v_lshl_add_u32 v12, v22, 5, v12
    v_lshrrev_b32 v13, 1, v9
    v_xor_b32 v13, s47, v13
    v_lshl_add_u32 v12, v13, 6, v12
    s_lshl_b32 s52, s47, 2
    v_add_u32 v13, s52, v20
    v_mul_u32_u24 v14, 3072, v13
    v_add_u32_e64 v14, v14, v12
    v_add_u32 v14, 131072, v14
    v_lshl_add_u32 v12, v13, 14, v12
    v_xor_b32 v13, 64, v12
    v_xor_b32 v15, 64, v14
    v_lshl_add_u32 v10, v20, 3, v9
    v_lshlrev_b32_e64 v10, 6, v10
    v_lshl_add_u32 v10, v21, 3, v10
    v_xor_b32_e64 v22, s47, v22
    v_lshl_add_u32 v10, v22, 5, v10
    s_lshl_b32 s52, s47, 16
    v_add_u32_e64 v10, s52, v10
    s_lshl_b32 s52, s47, 11
    s_add_u32 s52, s52, 155648
    v_lshlrev_b32 v4, 6, v20
    v_add_u32_e64 v4, s52, v4
    s_cmp_ge_u32 s40, 4
    s_cbranch_scc1 L_MODSKIP
    s_cmp_lg_u32 s40, 3
    s_cbranch_scc1 NOFL_1
    s_lshl_b32 s52, s41, 7
    s_lshl_b32 s59, s42, 2
    s_add_u32 s52, s52, s59
    s_add_u32 s52, s52, 4096
    v_mov_b32 v22, s3
    s_mov_b64 exec, 1
    buffer_store_dword v22, v2, s[12:15], s52 offen sc1
    s_mov_b64 exec, -1
NOFL_1:
    v_lshrrev_b32 v22, 4, v0
    v_lshlrev_b32 v22, 10, v22
    v_and_b32 v21, 15, v0
    v_lshl_add_u32 v22, v21, 4, v22
    s_mov_b32 s58, 65536
    s_mov_b32 s51, s56
    s_cmp_ge_u32 s40, 2
    s_cselect_b32 s52, 1.0, 0
    s_cselect_b32 s53, 0, 32
    v_and_b32 v60, 127, v0
    v_lshrrev_b32 v61, 1, v60
    v_lshlrev_b32 v61, 6, v61
    v_and_b32_e64 v60, 1, v60
    v_lshl_add_u32 v60, v60, 4, v61
    s_lshl_b32 s59, s91, 9
    v_xor_b32 v60, s59, v60
    s_add_u32 s53, s53, 155648
    v_add_u32 v60, s53, v60
    s_mov_b32 s101, 0
    s_mov_b32 s56, 0x0c0c0400
    s_mov_b32 s57, 0x04000c0c
L_MODC:
    buffer_load_dwordx4 v[36:39], v22, s[12:15], s58 offen offset:0 sc1
    buffer_load_dwordx4 v[40:43], v22, s[12:15], s58 offen offset:256 sc1
    buffer_load_dwordx4 v[44:47], v22, s[12:15], s58 offen offset:512 sc1
    buffer_load_dwordx4 v[48:51], v22, s[12:15], s58 offen offset:768 sc1
    s_add_u32 s101, s101, 1
    s_cmp_gt_u32 s101, 131072
    s_cbranch_scc1 L_MODK
    s_waitcnt vmcnt(0)
    s_nop 0
    v_perm_b32 v52, v37, v36, s56
    v_perm_b32 v53, v39, v38, s57
    v_bitop3_b32 v54, v52, v53, s50 bitop3:0x56
    v_perm_b32 v52, v41, v40, s56
    v_perm_b32 v53, v43, v42, s57
    v_bitop3_b32 v52, v52, v53, s50 bitop3:0x56
    v_or_b32_e64 v54, v54, v52
    v_perm_b32 v52, v45, v44, s56
    v_perm_b32 v53, v47, v46, s57
    v_bitop3_b32 v52, v52, v53, s50 bitop3:0x56
    v_or_b32_e64 v54, v54, v52
    v_perm_b32 v52, v49, v48, s56
    v_perm_b32 v53, v51, v50, s57
    v_bitop3_b32 v52, v52, v53, s50 bitop3:0x56
    v_or_b32 v54, v54, v52
    v_cmp_ne_u32 vcc, 0, v54
    s_nop 0
    s_cbranch_vccnz L_MODC
L_MODK:
    v_mov_b32 v52, 0xffffff00
    v_and_b32 v36, v52, v36
    v_and_b32 v37, v52, v37
    v_and_b32 v38, v52, v38
    v_and_b32 v39, v52, v39
    v_and_b32 v40, v52, v40
    v_and_b32 v41, v52, v41
    v_and_b32 v42, v52, v42
    v_and_b32 v43, v52, v43
    v_and_b32 v44, v52, v44
    v_and_b32 v45, v52, v45
    v_and_b32 v46, v52, v46
    v_and_b32 v47, v52, v47
    v_and_b32 v48, v52, v48
    v_and_b32 v49, v52, v49
    v_and_b32 v50, v52, v50
    v_and_b32 v51, v52, v51
    v_pk_add_f32 v[36:37], v[36:37], v[40:41]
    v_pk_add_f32 v[44:45], v[44:45], v[48:49]
    v_pk_add_f32 v[38:39], v[38:39], v[42:43]
    v_pk_add_f32 v[46:47], v[46:47], v[50:51]
    v_pk_add_f32 v[36:37], v[36:37], v[44:45]
    v_pk_add_f32 v[38:39], v[38:39], v[46:47]
    v_cvt_pk_bf16_f32 v40, v36, v37
    v_lshlrev_b32_e64 v36, 16, v40
    v_and_b32 v37, 0xffff0000, v40
    v_cvt_pk_bf16_f32 v42, v38, v39
    v_lshlrev_b32_e64 v38, 16, v42
    v_and_b32 v39, 0xffff0000, v42
    v_add_f32 v36, s52, v36
    v_add_f32 v37, s52, v37
    v_add_f32 v38, s52, v38
    v_add_f32 v39, s52, v39
    v_cvt_pk_bf16_f32 v40, v36, v37
    v_lshlrev_b32_e64 v36, 16, v40
    v_and_b32 v37, 0xffff0000, v40
    v_cvt_pk_bf16_f32 v42, v38, v39
    v_lshlrev_b32_e64 v38, 16, v42
    v_and_b32 v39, 0xffff0000, v42
    ds_write_b128 v60, v[36:39]
    s_mov_b32 s56, s51
L_MODSKIP:
    s_waitcnt lgkmcnt(0)
    s_barrier
    s_nop 0
    ds_read_b128 v[64:67], v17
    ds_read_b128 v[32:35], v4 offset:0
    ds_read_b128 v[36:39], v4 offset:16
    ds_read_b128 v[40:43], v4 offset:32
    ds_read_b128 v[44:47], v4 offset:48
    s_mov_b32 exec_lo, 0xffffff
    global_load_dword v31, v[24:25], off
    s_mov_b64 exec, 0x3fc
    global_load_dword v31, v[26:27], off
    s_mov_b64 exec, -1
    s_waitcnt lgkmcnt(4)
    v_add_f32 v64, v64, v66
    v_add_f32 v65, v65, v67
    v_mul_f32 v64, 0x3b000000, v64
    v_mul_f32 v65, 0x3b000000, v65
    v_fma_f32 v65, -v64, v64, v65
    v_max_f32_e64 v65, 0, v65
    v_add_f32 v65, 0x3727c5ac, v65
    v_rsq_f32 v16, v65
    s_nop 0
    v_mul_f32 v18, -v64, v16
    ds_read_b128 v[48:51], v4 offset:128
    ds_read_b128 v[52:55], v4 offset:144
    ds_read_b128 v[56:59], v4 offset:160
    ds_read_b128 v[60:63], v4 offset:176
    v_pk_fma_f32 v[128:129], v[128:129], v[16:17], v[18:19] op_sel_hi:[1,0,0]
    v_pk_fma_f32 v[130:131], v[130:131], v[16:17], v[18:19] op_sel_hi:[1,0,0]
    v_pk_fma_f32 v[132:133], v[132:133], v[16:17], v[18:19] op_sel_hi:[1,0,0]
    v_pk_fma_f32 v[134:135], v[134:135], v[16:17], v[18:19] op_sel_hi:[1,0,0]
    v_pk_fma_f32 v[240:241], v[240:241], v[16:17], v[18:19] op_sel_hi:[1,0,0]
    v_pk_fma_f32 v[242:243], v[242:243], v[16:17], v[18:19] op_sel_hi:[1,0,0]
    v_pk_fma_f32 v[244:245], v[244:245], v[16:17], v[18:19] op_sel_hi:[1,0,0]
    v_pk_fma_f32 v[246:247], v[246:247], v[16:17], v[18:19] op_sel_hi:[1,0,0]
    s_waitcnt lgkmcnt(4)
    s_nop 0
    v_pk_fma_f32 v[128:129], v[128:129], v[32:33], v[40:41]
    v_pk_fma_f32 v[130:131], v[130:131], v[34:35], v[42:43]
    v_pk_fma_f32 v[132:133], v[132:133], v[36:37], v[44:45]
    v_pk_fma_f32 v[134:135], v[134:135], v[38:39], v[46:47]
    v_cvt_pk_bf16_f32 v128, v128, v129
    v_cvt_pk_bf16_f32 v129, v130, v131
    v_cvt_pk_bf16_f32 v130, v132, v133
    v_cvt_pk_bf16_f32 v131, v134, v135
    ds_read_b128 v[32:35], v4 offset:256
    ds_read_b128 v[36:39], v4 offset:272
    ds_read_b128 v[40:43], v4 offset:288
    ds_read_b128 v[44:47], v4 offset:304
    v_pk_fma_f32 v[136:137], v[136:137], v[16:17], v[18:19] op_sel_hi:[1,0,0]
    v_pk_fma_f32 v[138:139], v[138:139], v[16:17], v[18:19] op_sel_hi:[1,0,0]
    v_pk_fma_f32 v[140:141], v[140:141], v[16:17], v[18:19] op_sel_hi:[1,0,0]
    v_pk_fma_f32 v[142:143], v[142:143], v[16:17], v[18:19] op_sel_hi:[1,0,0]
    v_pk_fma_f32 v[248:249], v[248:249], v[16:17], v[18:19] op_sel_hi:[1,0,0]
    v_pk_fma_f32 v[250:251], v[250:251], v[16:17], v[18:19] op_sel_hi:[1,0,0]
    v_pk_fma_f32 v[252:253], v[252:253], v[16:17], v[18:19] op_sel_hi:[1,0,0]
    v_pk_fma_f32 v[254:255], v[254:255], v[16:17], v[18:19] op_sel_hi:[1,0,0]
    s_waitcnt lgkmcnt(4)
    s_nop 0
    v_pk_fma_f32 v[136:137], v[136:137], v[48:49], v[56:57]
    v_pk_fma_f32 v[138:139], v[138:139], v[50:51], v[58:59]
    v_pk_fma_f32 v[140:141], v[140:141], v[52:53], v[60:61]
    v_pk_fma_f32 v[142:143], v[142:143], v[54:55], v[62:63]
    v_cvt_pk_bf16_f32 v136, v136, v137
    v_cvt_pk_bf16_f32 v137, v138, v139
    v_cvt_pk_bf16_f32 v138, v140, v141
    v_cvt_pk_bf16_f32 v139, v142, v143
    ds_read_b128 v[48:51], v4 offset:384
    ds_read_b128 v[52:55], v4 offset:400
    ds_read_b128 v[56:59], v4 offset:416
    ds_read_b128 v[60:63], v4 offset:432
    v_pk_fma_f32 v[144:145], v[144:145], v[16:17], v[18:19] op_sel_hi:[1,0,0]
    v_pk_fma_f32 v[146:147], v[146:147], v[16:17], v[18:19] op_sel_hi:[1,0,0]
    v_pk_fma_f32 v[148:149], v[148:149], v[16:17], v[18:19] op_sel_hi:[1,0,0]
    v_pk_fma_f32 v[150:151], v[150:151], v[16:17], v[18:19] op_sel_hi:[1,0,0]
    s_waitcnt lgkmcnt(4)
    s_nop 0
    v_pk_fma_f32 v[144:145], v[144:145], v[32:33], v[40:41]
    v_pk_fma_f32 v[146:147], v[146:147], v[34:35], v[42:43]
    v_pk_fma_f32 v[148:149], v[148:149], v[36:37], v[44:45]
    v_pk_fma_f32 v[150:151], v[150:151], v[38:39], v[46:47]
    v_cvt_pk_bf16_f32 v144, v144, v145
    v_cvt_pk_bf16_f32 v145, v146, v147
    v_cvt_pk_bf16_f32 v146, v148, v149
    v_cvt_pk_bf16_f32 v147, v150, v151
    ds_read_b128 v[32:35], v4 offset:512
    ds_read_b128 v[36:39], v4 offset:528
    ds_read_b128 v[40:43], v4 offset:544
    ds_read_b128 v[44:47], v4 offset:560
    v_pk_fma_f32 v[152:153], v[152:153], v[16:17], v[18:19] op_sel_hi:[1,0,0]
    v_pk_fma_f32 v[154:155], v[154:155], v[16:17], v[18:19] op_sel_hi:[1,0,0]
    v_pk_fma_f32 v[156:157], v[156:157], v[16:17], v[18:19] op_sel_hi:[1,0,0]
    v_pk_fma_f32 v[158:159], v[158:159], v[16:17], v[18:19] op_sel_hi:[1,0,0]
    s_waitcnt lgkmcnt(4)
    s_nop 0
    v_pk_fma_f32 v[152:153], v[152:153], v[48:49], v[56:57]
    v_pk_fma_f32 v[154:155], v[154:155], v[50:51], v[58:59]
    v_pk_fma_f32 v[156:157], v[156:157], v[52:53], v[60:61]
    v_pk_fma_f32 v[158:159], v[158:159], v[54:55], v[62:63]
    v_cvt_pk_bf16_f32 v152, v152, v153
    v_cvt_pk_bf16_f32 v153, v154, v155
    v_cvt_pk_bf16_f32 v154, v156, v157
    v_cvt_pk_bf16_f32 v155, v158, v159
    ds_read_b128 v[48:51], v4 offset:640
    ds_read_b128 v[52:55], v4 offset:656
    ds_read_b128 v[56:59], v4 offset:672
    ds_read_b128 v[60:63], v4 offset:688
    v_pk_fma_f32 v[160:161], v[160:161], v[16:17], v[18:19] op_sel_hi:[1,0,0]
    v_pk_fma_f32 v[162:163], v[162:163], v[16:17], v[18:19] op_sel_hi:[1,0,0]
    v_pk_fma_f32 v[164:165], v[164:165], v[16:17], v[18:19] op_sel_hi:[1,0,0]
    v_pk_fma_f32 v[166:167], v[166:167], v[16:17], v[18:19] op_sel_hi:[1,0,0]
    s_waitcnt lgkmcnt(4)
    s_nop 0
    v_pk_fma_f32 v[160:161], v[160:161], v[32:33], v[40:41]
    v_pk_fma_f32 v[162:163], v[162:163], v[34:35], v[42:43]
    v_pk_fma_f32 v[164:165], v[164:165], v[36:37], v[44:45]
    v_pk_fma_f32 v[166:167], v[166:167], v[38:39], v[46:47]
    v_cvt_pk_bf16_f32 v160, v160, v161
    v_cvt_pk_bf16_f32 v161, v162, v163
    v_cvt_pk_bf16_f32 v162, v164, v165
    v_cvt_pk_bf16_f32 v163, v166, v167
    ds_read_b128 v[32:35], v4 offset:768
    ds_read_b128 v[36:39], v4 offset:784
    ds_read_b128 v[40:43], v4 offset:800
    ds_read_b128 v[44:47], v4 offset:816
    v_pk_fma_f32 v[168:169], v[168:169], v[16:17], v[18:19] op_sel_hi:[1,0,0]
    v_pk_fma_f32 v[170:171], v[170:171], v[16:17], v[18:19] op_sel_hi:[1,0,0]
    v_pk_fma_f32 v[172:173], v[172:173], v[16:17], v[18:19] op_sel_hi:[1,0,0]
    v_pk_fma_f32 v[174:175], v[174:175], v[16:17], v[18:19] op_sel_hi:[1,0,0]
    s_waitcnt lgkmcnt(4)
    s_nop 0
    v_pk_fma_f32 v[168:169], v[168:169], v[48:49], v[56:57]
    v_pk_fma_f32 v[170:171], v[170:171], v[50:51], v[58:59]
    v_pk_fma_f32 v[172:173], v[172:173], v[52:53], v[60:61]
    v_pk_fma_f32 v[174:175], v[174:175], v[54:55], v[62:63]
    v_cvt_pk_bf16_f32 v168, v168, v169
    v_cvt_pk_bf16_f32 v169, v170, v171
    v_cvt_pk_bf16_f32 v170, v172, v173
    v_cvt_pk_bf16_f32 v171, v174, v175
    ds_read_b128 v[48:51], v4 offset:896
    ds_read_b128 v[52:55], v4 offset:912
    ds_read_b128 v[56:59], v4 offset:928
    ds_read_b128 v[60:63], v4 offset:944
    v_pk_fma_f32 v[176:177], v[176:177], v[16:17], v[18:19] op_sel_hi:[1,0,0]
    v_pk_fma_f32 v[178:179], v[178:179], v[16:17], v[18:19] op_sel_hi:[1,0,0]
    v_pk_fma_f32 v[180:181], v[180:181], v[16:17], v[18:19] op_sel_hi:[1,0,0]
    v_pk_fma_f32 v[182:183], v[182:183], v[16:17], v[18:19] op_sel_hi:[1,0,0]
    s_waitcnt lgkmcnt(4)
    s_nop 0
    v_pk_fma_f32 v[176:177], v[176:177], v[32:33], v[40:41]
    v_pk_fma_f32 v[178:179], v[178:179], v[34:35], v[42:43]
    v_pk_fma_f32 v[180:181], v[180:181], v[36:37], v[44:45]
    v_pk_fma_f32 v[182:183], v[182:183], v[38:39], v[46:47]
    v_cvt_pk_bf16_f32 v176, v176, v177
    v_cvt_pk_bf16_f32 v177, v178, v179
    v_cvt_pk_bf16_f32 v178, v180, v181
    v_cvt_pk_bf16_f32 v179, v182, v183
    ds_read_b128 v[32:35], v4 offset:1024
    ds_read_b128 v[36:39], v4 offset:1040
    ds_read_b128 v[40:43], v4 offset:1056
    ds_read_b128 v[44:47], v4 offset:1072
    v_pk_fma_f32 v[184:185], v[184:185], v[16:17], v[18:19] op_sel_hi:[1,0,0]
    v_pk_fma_f32 v[186:187], v[186:187], v[16:17], v[18:19] op_sel_hi:[1,0,0]
    v_pk_fma_f32 v[188:189], v[188:189], v[16:17], v[18:19] op_sel_hi:[1,0,0]
    v_pk_fma_f32 v[190:191], v[190:191], v[16:17], v[18:19] op_sel_hi:[1,0,0]
    s_waitcnt lgkmcnt(4)
    s_nop 0
    v_pk_fma_f32 v[184:185], v[184:185], v[48:49], v[56:57]
    v_pk_fma_f32 v[186:187], v[186:187], v[50:51], v[58:59]
    v_pk_fma_f32 v[188:189], v[188:189], v[52:53], v[60:61]
    v_pk_fma_f32 v[190:191], v[190:191], v[54:55], v[62:63]
    v_cvt_pk_bf16_f32 v184, v184, v185
    v_cvt_pk_bf16_f32 v185, v186, v187
    v_cvt_pk_bf16_f32 v186, v188, v189
    v_cvt_pk_bf16_f32 v187, v190, v191
    ds_read_b128 v[48:51], v4 offset:1152
    ds_read_b128 v[52:55], v4 offset:1168
    ds_read_b128 v[56:59], v4 offset:1184
    ds_read_b128 v[60:63], v4 offset:1200
    v_pk_fma_f32 v[192:193], v[192:193], v[16:17], v[18:19] op_sel_hi:[1,0,0]
    v_pk_fma_f32 v[194:195], v[194:195], v[16:17], v[18:19] op_sel_hi:[1,0,0]
    v_pk_fma_f32 v[196:197], v[196:197], v[16:17], v[18:19] op_sel_hi:[1,0,0]
    v_pk_fma_f32 v[198:199], v[198:199], v[16:17], v[18:19] op_sel_hi:[1,0,0]
    s_waitcnt lgkmcnt(4)
    s_nop 0
    v_pk_fma_f32 v[192:193], v[192:193], v[32:33], v[40:41]
    v_pk_fma_f32 v[194:195], v[194:195], v[34:35], v[42:43]
    v_pk_fma_f32 v[196:197], v[196:197], v[36:37], v[44:45]
    v_pk_fma_f32 v[198:199], v[198:199], v[38:39], v[46:47]
    v_cvt_pk_bf16_f32 v192, v192, v193
    v_cvt_pk_bf16_f32 v193, v194, v195
    v_cvt_pk_bf16_f32 v194, v196, v197
    v_cvt_pk_bf16_f32 v195, v198, v199
    ds_read_b128 v[32:35], v4 offset:1280
    ds_read_b128 v[36:39], v4 offset:1296
    ds_read_b128 v[40:43], v4 offset:1312
    ds_read_b128 v[44:47], v4 offset:1328
    v_pk_fma_f32 v[200:201], v[200:201], v[16:17], v[18:19] op_sel_hi:[1,0,0]
    v_pk_fma_f32 v[202:203], v[202:203], v[16:17], v[18:19] op_sel_hi:[1,0,0]
    v_pk_fma_f32 v[204:205], v[204:205], v[16:17], v[18:19] op_sel_hi:[1,0,0]
    v_pk_fma_f32 v[206:207], v[206:207], v[16:17], v[18:19] op_sel_hi:[1,0,0]
    s_waitcnt lgkmcnt(4)
    s_nop 0
    v_pk_fma_f32 v[200:201], v[200:201], v[48:49], v[56:57]
    v_pk_fma_f32 v[202:203], v[202:203], v[50:51], v[58:59]
    v_pk_fma_f32 v[204:205], v[204:205], v[52:53], v[60:61]
    v_pk_fma_f32 v[206:207], v[206:207], v[54:55], v[62:63]
    v_cvt_pk_bf16_f32 v200, v200, v201
    v_cvt_pk_bf16_f32 v201, v202, v203
    v_cvt_pk_bf16_f32 v202, v204, v205
    v_cvt_pk_bf16_f32 v203, v206, v207
    ds_read_b128 v[48:51], v4 offset:1408
    ds_read_b128 v[52:55], v4 offset:1424
    ds_read_b128 v[56:59], v4 offset:1440
    ds_read_b128 v[60:63], v4 offset:1456
    v_pk_fma_f32 v[208:209], v[208:209], v[16:17], v[18:19] op_sel_hi:[1,0,0]
    v_pk_fma_f32 v[210:211], v[210:211], v[16:17], v[18:19] op_sel_hi:[1,0,0]
    v_pk_fma_f32 v[212:213], v[212:213], v[16:17], v[18:19] op_sel_hi:[1,0,0]
    v_pk_fma_f32 v[214:215], v[214:215], v[16:17], v[18:19] op_sel_hi:[1,0,0]
    s_waitcnt lgkmcnt(4)
    s_nop 0
    v_pk_fma_f32 v[208:209], v[208:209], v[32:33], v[40:41]
    v_pk_fma_f32 v[210:211], v[210:211], v[34:35], v[42:43]
    v_pk_fma_f32 v[212:213], v[212:213], v[36:37], v[44:45]
    v_pk_fma_f32 v[214:215], v[214:215], v[38:39], v[46:47]
    v_cvt_pk_bf16_f32 v208, v208, v209
    v_cvt_pk_bf16_f32 v209, v210, v211
    v_cvt_pk_bf16_f32 v210, v212, v213
    v_cvt_pk_bf16_f32 v211, v214, v215
    ds_read_b128 v[32:35], v4 offset:1536
    ds_read_b128 v[36:39], v4 offset:1552
    ds_read_b128 v[40:43], v4 offset:1568
    ds_read_b128 v[44:47], v4 offset:1584
    v_pk_fma_f32 v[216:217], v[216:217], v[16:17], v[18:19] op_sel_hi:[1,0,0]
    v_pk_fma_f32 v[218:219], v[218:219], v[16:17], v[18:19] op_sel_hi:[1,0,0]
    v_pk_fma_f32 v[220:221], v[220:221], v[16:17], v[18:19] op_sel_hi:[1,0,0]
    v_pk_fma_f32 v[222:223], v[222:223], v[16:17], v[18:19] op_sel_hi:[1,0,0]
    s_waitcnt lgkmcnt(4)
    s_nop 0
    v_pk_fma_f32 v[216:217], v[216:217], v[48:49], v[56:57]
    v_pk_fma_f32 v[218:219], v[218:219], v[50:51], v[58:59]
    v_pk_fma_f32 v[220:221], v[220:221], v[52:53], v[60:61]
    v_pk_fma_f32 v[222:223], v[222:223], v[54:55], v[62:63]
    v_cvt_pk_bf16_f32 v216, v216, v217
    v_cvt_pk_bf16_f32 v217, v218, v219
    v_cvt_pk_bf16_f32 v218, v220, v221
    v_cvt_pk_bf16_f32 v219, v222, v223
    ds_read_b128 v[48:51], v4 offset:1664
    ds_read_b128 v[52:55], v4 offset:1680
    ds_read_b128 v[56:59], v4 offset:1696
    ds_read_b128 v[60:63], v4 offset:1712
    v_pk_fma_f32 v[224:225], v[224:225], v[16:17], v[18:19] op_sel_hi:[1,0,0]
    v_pk_fma_f32 v[226:227], v[226:227], v[16:17], v[18:19] op_sel_hi:[1,0,0]
    v_pk_fma_f32 v[228:229], v[228:229], v[16:17], v[18:19] op_sel_hi:[1,0,0]
    v_pk_fma_f32 v[230:231], v[230:231], v[16:17], v[18:19] op_sel_hi:[1,0,0]
    s_waitcnt lgkmcnt(4)
    s_nop 0
    v_pk_fma_f32 v[224:225], v[224:225], v[32:33], v[40:41]
    v_pk_fma_f32 v[226:227], v[226:227], v[34:35], v[42:43]
    v_pk_fma_f32 v[228:229], v[228:229], v[36:37], v[44:45]
    v_pk_fma_f32 v[230:231], v[230:231], v[38:39], v[46:47]
    v_cvt_pk_bf16_f32 v224, v224, v225
    v_cvt_pk_bf16_f32 v225, v226, v227
    v_cvt_pk_bf16_f32 v226, v228, v229
    v_cvt_pk_bf16_f32 v227, v230, v231
    ds_read_b128 v[32:35], v4 offset:1792
    ds_read_b128 v[36:39], v4 offset:1808
    ds_read_b128 v[40:43], v4 offset:1824
    ds_read_b128 v[44:47], v4 offset:1840
    v_pk_fma_f32 v[232:233], v[232:233], v[16:17], v[18:19] op_sel_hi:[1,0,0]
    v_pk_fma_f32 v[234:235], v[234:235], v[16:17], v[18:19] op_sel_hi:[1,0,0]
    v_pk_fma_f32 v[236:237], v[236:237], v[16:17], v[18:19] op_sel_hi:[1,0,0]
    v_pk_fma_f32 v[238:239], v[238:239], v[16:17], v[18:19] op_sel_hi:[1,0,0]
    s_waitcnt lgkmcnt(4)
    s_nop 0
    v_pk_fma_f32 v[232:233], v[232:233], v[48:49], v[56:57]
    v_pk_fma_f32 v[234:235], v[234:235], v[50:51], v[58:59]
    v_pk_fma_f32 v[236:237], v[236:237], v[52:53], v[60:61]
    v_pk_fma_f32 v[238:239], v[238:239], v[54:55], v[62:63]
    v_cvt_pk_bf16_f32 v232, v232, v233
    v_cvt_pk_bf16_f32 v233, v234, v235
    v_cvt_pk_bf16_f32 v234, v236, v237
    v_cvt_pk_bf16_f32 v235, v238, v239
    s_waitcnt vmcnt(2)
    s_barrier
    s_cmp_lg_u32 s45, 0
    s_cbranch_scc1 L_KVV
    ds_read_b64_tr_b16 v[96:97], v14 offset:0
    ds_read_b64_tr_b16 v[98:99], v14 offset:512
    ds_read_b64_tr_b16 v[100:101], v15 offset:0
    ds_read_b64_tr_b16 v[102:103], v15 offset:512
    ds_read_b64_tr_b16 v[104:105], v14 offset:6144
    ds_read_b64_tr_b16 v[106:107], v14 offset:6656
    ds_read_b64_tr_b16 v[108:109], v15 offset:6144
    ds_read_b64_tr_b16 v[110:111], v15 offset:6656
    s_waitcnt lgkmcnt(0)
    s_nop 0
    v_mfma_f32_32x32x16_bf16 v[64:79], v[96:99], v[128:131], 0
    ds_read_b64_tr_b16 v[112:113], v14 offset:1024
    ds_read_b64_tr_b16 v[114:115], v14 offset:1536
    ds_read_b64_tr_b16 v[116:117], v15 offset:1024
    ds_read_b64_tr_b16 v[118:119], v15 offset:1536
    ds_read_b64_tr_b16 v[120:121], v14 offset:7168
    ds_read_b64_tr_b16 v[122:123], v14 offset:7680
    v_mfma_f32_32x32x16_bf16 v[80:95], v[100:103], v[128:131], 0
    ds_read_b64_tr_b16 v[124:125], v15 offset:7168
    ds_read_b64_tr_b16 v[126:127], v15 offset:7680
    ds_read_b128 v[48:51], v4 offset:1920
    ds_read_b128 v[52:55], v4 offset:1936
    ds_read_b128 v[56:59], v4 offset:1952
    ds_read_b128 v[60:63], v4 offset:1968
    v_mfma_f32_32x32x16_bf16 v[64:79], v[104:107], v[136:139], v[64:79]
    v_fma_f32 v240, v240, v32, v40
    v_fma_f32 v241, v241, v33, v41
    v_fma_f32 v242, v242, v34, v42
    v_fma_f32 v243, v243, v35, v43
    v_fma_f32 v244, v244, v36, v44
    v_fma_f32 v245, v245, v37, v45
    v_mfma_f32_32x32x16_bf16 v[80:95], v[108:111], v[136:139], v[80:95]
    v_fma_f32 v246, v246, v38, v46
    v_fma_f32 v247, v247, v39, v47
    v_cvt_pk_bf16_f32 v240, v240, v241
    v_cvt_pk_bf16_f32 v241, v242, v243
    v_cvt_pk_bf16_f32 v242, v244, v245
    v_cvt_pk_bf16_f32 v243, v246, v247
    s_waitcnt lgkmcnt(0)
    s_nop 0
    v_mfma_f32_32x32x16_bf16 v[64:79], v[112:115], v[144:147], v[64:79]
    ds_read_b64_tr_b16 v[96:97], v14 offset:2048
    ds_read_b64_tr_b16 v[98:99], v14 offset:2560
    ds_read_b64_tr_b16 v[100:101], v15 offset:2048
    ds_read_b64_tr_b16 v[102:103], v15 offset:2560
    ds_read_b64_tr_b16 v[104:105], v14 offset:8192
    ds_read_b64_tr_b16 v[106:107], v14 offset:8704
    v_mfma_f32_32x32x16_bf16 v[80:95], v[116:119], v[144:147], v[80:95]
    ds_read_b64_tr_b16 v[108:109], v15 offset:8192
    ds_read_b64_tr_b16 v[110:111], v15 offset:8704
    v_mfma_f32_32x32x16_bf16 v[64:79], v[120:123], v[152:155], v[64:79]
    v_fma_f32 v248, v248, v48, v56
    v_fma_f32 v249, v249, v49, v57
    v_fma_f32 v250, v250, v50, v58
    v_fma_f32 v251, v251, v51, v59
    v_fma_f32 v252, v252, v52, v60
    v_fma_f32 v253, v253, v53, v61
    v_mfma_f32_32x32x16_bf16 v[80:95], v[124:127], v[152:155], v[80:95]
    v_fma_f32 v254, v254, v54, v62
    v_fma_f32 v255, v255, v55, v63
    v_cvt_pk_bf16_f32 v248, v248, v249
    v_cvt_pk_bf16_f32 v249, v250, v251
    v_cvt_pk_bf16_f32 v250, v252, v253
    v_cvt_pk_bf16_f32 v251, v254, v255
    s_mov_b32 s53, 0
    buffer_load_dword v16, v30, s[16:19], s53 offen
    s_add_u32 s53, s53, s96
    buffer_load_dword v17, v30, s[16:19], s53 offen
    s_waitcnt lgkmcnt(0)
    s_nop 0
    v_mfma_f32_32x32x16_bf16 v[64:79], v[96:99], v[160:163], v[64:79]
    ds_read_b64_tr_b16 v[112:113], v12 offset:0
    ds_read_b64_tr_b16 v[114:115], v12 offset:512
    ds_read_b64_tr_b16 v[116:117], v13 offset:0
    ds_read_b64_tr_b16 v[118:119], v13 offset:512
    ds_read_b64_tr_b16 v[120:121], v12 offset:32768
    ds_read_b64_tr_b16 v[122:123], v12 offset:33280
    v_mfma_f32_32x32x16_bf16 v[80:95], v[100:103], v[160:163], v[80:95]
    ds_read_b64_tr_b16 v[124:125], v13 offset:32768
    ds_read_b64_tr_b16 v[126:127], v13 offset:33280
    v_mfma_f32_32x32x16_bf16 v[64:79], v[104:107], v[168:171], v[64:79]
    v_mfma_f32_32x32x16_bf16 v[80:95], v[108:111], v[168:171], v[80:95]
    s_add_u32 s53, s53, s96
    buffer_load_dword v18, v30, s[16:19], s53 offen
    s_add_u32 s53, s53, s96
    buffer_load_dword v19, v30, s[16:19], s53 offen
    s_waitcnt lgkmcnt(0)
    s_nop 0
    v_mfma_f32_32x32x16_bf16 v[64:79], v[112:115], v[176:179], v[64:79]
    ds_read_b64_tr_b16 v[96:97], v12 offset:1024
    ds_read_b64_tr_b16 v[98:99], v12 offset:1536
    ds_read_b64_tr_b16 v[100:101], v13 offset:1024
    ds_read_b64_tr_b16 v[102:103], v13 offset:1536
    ds_read_b64_tr_b16 v[104:105], v12 offset:33792
    ds_read_b64_tr_b16 v[106:107], v12 offset:34304
    v_mfma_f32_32x32x16_bf16 v[80:95], v[116:119], v[176:179], v[80:95]
    ds_read_b64_tr_b16 v[108:109], v13 offset:33792
    ds_read_b64_tr_b16 v[110:111], v13 offset:34304
    v_mfma_f32_32x32x16_bf16 v[64:79], v[120:123], v[184:187], v[64:79]
    v_mfma_f32_32x32x16_bf16 v[80:95], v[124:127], v[184:187], v[80:95]
    s_mov_b32 s53, s97
    buffer_load_dword v24, v30, s[16:19], s53 offen
    s_add_u32 s53, s53, s96
    buffer_load_dword v25, v30, s[16:19], s53 offen
    s_waitcnt lgkmcnt(0)
    s_nop 0
    v_mfma_f32_32x32x16_bf16 v[64:79], v[96:99], v[192:195], v[64:79]
    ds_read_b64_tr_b16 v[112:113], v12 offset:2048
    ds_read_b64_tr_b16 v[114:115], v12 offset:2560
    ds_read_b64_tr_b16 v[116:117], v13 offset:2048
    ds_read_b64_tr_b16 v[118:119], v13 offset:2560
    ds_read_b64_tr_b16 v[120:121], v12 offset:34816
    ds_read_b64_tr_b16 v[122:123], v12 offset:35328
    v_mfma_f32_32x32x16_bf16 v[80:95], v[100:103], v[192:195], v[80:95]
    ds_read_b64_tr_b16 v[124:125], v13 offset:34816
    ds_read_b64_tr_b16 v[126:127], v13 offset:35328
    v_mfma_f32_32x32x16_bf16 v[64:79], v[104:107], v[200:203], v[64:79]
    v_mfma_f32_32x32x16_bf16 v[80:95], v[108:111], v[200:203], v[80:95]
    s_add_u32 s53, s53, s96
    buffer_load_dword v26, v30, s[16:19], s53 offen
    s_add_u32 s53, s53, s96
    buffer_load_dword v27, v30, s[16:19], s53 offen
    s_waitcnt lgkmcnt(0)
    s_nop 0
    v_mfma_f32_32x32x16_bf16 v[64:79], v[112:115], v[208:211], v[64:79]
    ds_read_b64_tr_b16 v[96:97], v12 offset:3072
    ds_read_b64_tr_b16 v[98:99], v12 offset:3584
    ds_read_b64_tr_b16 v[100:101], v13 offset:3072
    ds_read_b64_tr_b16 v[102:103], v13 offset:3584
    ds_read_b64_tr_b16 v[104:105], v12 offset:35840
    ds_read_b64_tr_b16 v[106:107], v12 offset:36352
    v_mfma_f32_32x32x16_bf16 v[80:95], v[116:119], v[208:211], v[80:95]
    ds_read_b64_tr_b16 v[108:109], v13 offset:35840
    ds_read_b64_tr_b16 v[110:111], v13 offset:36352
    v_mfma_f32_32x32x16_bf16 v[64:79], v[120:123], v[216:219], v[64:79]
    v_mfma_f32_32x32x16_bf16 v[80:95], v[124:127], v[216:219], v[80:95]
    s_sub_u32 s58, s2, 64
    s_cmp_ge_u32 s40, 4
    s_cselect_b32 s58, 128, s58
    s_cmp_ge_u32 s58, 128
    s_cbranch_scc1 NOPD_2
    v_lshrrev_b32 v21, 3, v1
    v_lshlrev_b32_e64 v23, 1, v21
    v_mul_u32_u24 v21, 6144, v21
    v_and_b32_e64 v22, 7, v1
    v_lshl_add_u32 v21, v22, 4, v21
    s_and_b32 s52, s2, 3
    s_and_b32 s53, s40, 3
    s_lshl_b32 s53, s53, 6
    s_lshl_b32 s59, s52, 8
    s_add_u32 s53, s53, s59
    buffer_load_ushort v164, v23, s[24:27], s53 offen offset:0
    buffer_load_ushort v165, v23, s[24:27], s53 offen offset:16
    buffer_load_ushort v166, v23, s[24:27], s53 offen offset:32
    buffer_load_ushort v167, v23, s[24:27], s53 offen offset:48
    s_lshr_b32 s52, s2, 2
    s_lshl_b32 s52, s52, 7
    s_mul_i32 s59, s53, 3072
    s_add_u32 s52, s52, s59
    buffer_load_dwordx4 v[132:135], v21, s[20:23], s52 offen
    s_add_u32 s52, s52, 49152
    buffer_load_dwordx4 v[140:143], v21, s[20:23], s52 offen
    s_add_u32 s52, s52, 49152
    buffer_load_dwordx4 v[148:151], v21, s[20:23], s52 offen
    s_add_u32 s52, s52, 49152
    buffer_load_dwordx4 v[156:159], v21, s[20:23], s52 offen
NOPD_2:
    s_xor_b32 s52, s91, 0
    s_mul_i32 s52, s52, 196608
    s_add_u32 s52, s52, s56
    s_add_u32 m0, s54, 5120
    s_nop 0
    buffer_load_dwordx4 v11, s[8:11], s52 offen lds
    s_waitcnt lgkmcnt(0)
    v_mfma_f32_32x32x16_bf16 v[64:79], v[96:99], v[224:227], v[64:79]
    ds_read_b64_tr_b16 v[112:113], v12 offset:4096
    ds_read_b64_tr_b16 v[114:115], v12 offset:4608
    ds_read_b64_tr_b16 v[116:117], v13 offset:4096
    ds_read_b64_tr_b16 v[118:119], v13 offset:4608
    ds_read_b64_tr_b16 v[120:121], v12 offset:36864
    ds_read_b64_tr_b16 v[122:123], v12 offset:37376
    v_mfma_f32_32x32x16_bf16 v[80:95], v[100:103], v[224:227], v[80:95]
    ds_read_b64_tr_b16 v[124:125], v13 offset:36864
    ds_read_b64_tr_b16 v[126:127], v13 offset:37376
    v_mfma_f32_32x32x16_bf16 v[64:79], v[104:107], v[232:235], v[64:79]
    v_mfma_f32_32x32x16_bf16 v[80:95], v[108:111], v[232:235], v[80:95]
    s_xor_b32 s52, s91, 1
    s_mul_i32 s52, s52, 196608
    s_add_u32 s52, s52, s56
    s_add_u32 m0, s54, 6144
    s_nop 0
    buffer_load_dwordx4 v11, s[8:11], s52 offen lds
    s_xor_b32 s52, s91, 2
    s_mul_i32 s52, s52, 196608
    s_add_u32 s52, s52, s56
    s_add_u32 m0, s54, 7168
    s_nop 0
    buffer_load_dwordx4 v11, s[8:11], s52 offen lds
    s_waitcnt lgkmcnt(0)
    v_mfma_f32_32x32x16_bf16 v[64:79], v[112:115], v[240:243], v[64:79]
    v_mfma_f32_32x32x16_bf16 v[80:95], v[116:119], v[240:243], v[80:95]
    v_mfma_f32_32x32x16_bf16 v[64:79], v[120:123], v[248:251], v[64:79]
    v_mfma_f32_32x32x16_bf16 v[80:95], v[124:127], v[248:251], v[80:95]
    s_xor_b32 s52, s91, 3
    s_mul_i32 s52, s52, 196608
    s_add_u32 s52, s52, s56
    s_add_u32 m0, s54, 8192
    s_nop 0
    buffer_load_dwordx4 v11, s[8:11], s52 offen lds
    s_branch L_KVDONE
L_KVV:
    s_nop 0
    ds_read_b64_tr_b16 v[96:97], v14 offset:0
    ds_read_b64_tr_b16 v[98:99], v14 offset:512
    ds_read_b64_tr_b16 v[100:101], v15 offset:0
    ds_read_b64_tr_b16 v[102:103], v15 offset:512
    ds_read_b64_tr_b16 v[104:105], v14 offset:6144
    ds_read_b64_tr_b16 v[106:107], v14 offset:6656
    ds_read_b64_tr_b16 v[108:109], v15 offset:6144
    ds_read_b64_tr_b16 v[110:111], v15 offset:6656
    s_waitcnt lgkmcnt(0)
    s_nop 0
    v_mfma_f32_32x32x16_bf16 v[64:79], v[128:131], v[96:99], 0
    ds_read_b64_tr_b16 v[112:113], v14 offset:1024
    ds_read_b64_tr_b16 v[114:115], v14 offset:1536
    ds_read_b64_tr_b16 v[116:117], v15 offset:1024
    ds_read_b64_tr_b16 v[118:119], v15 offset:1536
    ds_read_b64_tr_b16 v[120:121], v14 offset:7168
    ds_read_b64_tr_b16 v[122:123], v14 offset:7680
    v_mfma_f32_32x32x16_bf16 v[80:95], v[128:131], v[100:103], 0
    ds_read_b64_tr_b16 v[124:125], v15 offset:7168
    ds_read_b64_tr_b16 v[126:127], v15 offset:7680
    ds_read_b128 v[48:51], v4 offset:1920
    ds_read_b128 v[52:55], v4 offset:1936
    ds_read_b128 v[56:59], v4 offset:1952
    ds_read_b128 v[60:63], v4 offset:1968
    v_mfma_f32_32x32x16_bf16 v[64:79], v[136:139], v[104:107], v[64:79]
    v_fma_f32 v240, v240, v32, v40
    v_fma_f32 v241, v241, v33, v41
    v_fma_f32 v242, v242, v34, v42
    v_fma_f32 v243, v243, v35, v43
    v_fma_f32 v244, v244, v36, v44
    v_fma_f32 v245, v245, v37, v45
    v_mfma_f32_32x32x16_bf16 v[80:95], v[136:139], v[108:111], v[80:95]
    v_fma_f32 v246, v246, v38, v46
    v_fma_f32 v247, v247, v39, v47
    v_cvt_pk_bf16_f32 v240, v240, v241
    v_cvt_pk_bf16_f32 v241, v242, v243
    v_cvt_pk_bf16_f32 v242, v244, v245
    v_cvt_pk_bf16_f32 v243, v246, v247
    s_waitcnt lgkmcnt(0)
    s_nop 0
    v_mfma_f32_32x32x16_bf16 v[64:79], v[144:147], v[112:115], v[64:79]
    ds_read_b64_tr_b16 v[96:97], v14 offset:2048
    ds_read_b64_tr_b16 v[98:99], v14 offset:2560
    ds_read_b64_tr_b16 v[100:101], v15 offset:2048
    ds_read_b64_tr_b16 v[102:103], v15 offset:2560
    ds_read_b64_tr_b16 v[104:105], v14 offset:8192
    ds_read_b64_tr_b16 v[106:107], v14 offset:8704
    v_mfma_f32_32x32x16_bf16 v[80:95], v[144:147], v[116:119], v[80:95]
    ds_read_b64_tr_b16 v[108:109], v15 offset:8192
    ds_read_b64_tr_b16 v[110:111], v15 offset:8704
    v_mfma_f32_32x32x16_bf16 v[64:79], v[152:155], v[120:123], v[64:79]
    v_fma_f32 v248, v248, v48, v56
    v_fma_f32 v249, v249, v49, v57
    v_fma_f32 v250, v250, v50, v58
    v_fma_f32 v251, v251, v51, v59
    v_fma_f32 v252, v252, v52, v60
    v_fma_f32 v253, v253, v53, v61
    v_mfma_f32_32x32x16_bf16 v[80:95], v[152:155], v[124:127], v[80:95]
    v_fma_f32 v254, v254, v54, v62
    v_fma_f32 v255, v255, v55, v63
    v_cvt_pk_bf16_f32 v248, v248, v249
    v_cvt_pk_bf16_f32 v249, v250, v251
    v_cvt_pk_bf16_f32 v250, v252, v253
    v_cvt_pk_bf16_f32 v251, v254, v255
    s_mov_b32 s53, 0
    buffer_load_dword v16, v30, s[16:19], s53 offen
    s_add_u32 s53, s53, s96
    buffer_load_dword v17, v30, s[16:19], s53 offen
    s_waitcnt lgkmcnt(0)
    s_nop 0
    v_mfma_f32_32x32x16_bf16 v[64:79], v[160:163], v[96:99], v[64:79]
    ds_read_b64_tr_b16 v[112:113], v12 offset:0
    ds_read_b64_tr_b16 v[114:115], v12 offset:512
    ds_read_b64_tr_b16 v[116:117], v13 offset:0
    ds_read_b64_tr_b16 v[118:119], v13 offset:512
    ds_read_b64_tr_b16 v[120:121], v12 offset:32768
    ds_read_b64_tr_b16 v[122:123], v12 offset:33280
    v_mfma_f32_32x32x16_bf16 v[80:95], v[160:163], v[100:103], v[80:95]
    ds_read_b64_tr_b16 v[124:125], v13 offset:32768
    ds_read_b64_tr_b16 v[126:127], v13 offset:33280
    v_mfma_f32_32x32x16_bf16 v[64:79], v[168:171], v[104:107], v[64:79]
    v_mfma_f32_32x32x16_bf16 v[80:95], v[168:171], v[108:111], v[80:95]
    s_add_u32 s53, s53, s96
    buffer_load_dword v18, v30, s[16:19], s53 offen
    s_add_u32 s53, s53, s96
    buffer_load_dword v19, v30, s[16:19], s53 offen
    s_waitcnt lgkmcnt(0)
    s_nop 0
    v_mfma_f32_32x32x16_bf16 v[64:79], v[176:179], v[112:115], v[64:79]
    ds_read_b64_tr_b16 v[96:97], v12 offset:1024
    ds_read_b64_tr_b16 v[98:99], v12 offset:1536
    ds_read_b64_tr_b16 v[100:101], v13 offset:1024
    ds_read_b64_tr_b16 v[102:103], v13 offset:1536
    ds_read_b64_tr_b16 v[104:105], v12 offset:33792
    ds_read_b64_tr_b16 v[106:107], v12 offset:34304
    v_mfma_f32_32x32x16_bf16 v[80:95], v[176:179], v[116:119], v[80:95]
    ds_read_b64_tr_b16 v[108:109], v13 offset:33792
    ds_read_b64_tr_b16 v[110:111], v13 offset:34304
    v_mfma_f32_32x32x16_bf16 v[64:79], v[184:187], v[120:123], v[64:79]
    v_mfma_f32_32x32x16_bf16 v[80:95], v[184:187], v[124:127], v[80:95]
    s_mov_b32 s53, s97
    buffer_load_dword v24, v30, s[16:19], s53 offen
    s_add_u32 s53, s53, s96
    buffer_load_dword v25, v30, s[16:19], s53 offen
    s_waitcnt lgkmcnt(0)
    s_nop 0
    v_mfma_f32_32x32x16_bf16 v[64:79], v[192:195], v[96:99], v[64:79]
    ds_read_b64_tr_b16 v[112:113], v12 offset:2048
    ds_read_b64_tr_b16 v[114:115], v12 offset:2560
    ds_read_b64_tr_b16 v[116:117], v13 offset:2048
    ds_read_b64_tr_b16 v[118:119], v13 offset:2560
    ds_read_b64_tr_b16 v[120:121], v12 offset:34816
    ds_read_b64_tr_b16 v[122:123], v12 offset:35328
    v_mfma_f32_32x32x16_bf16 v[80:95], v[192:195], v[100:103], v[80:95]
    ds_read_b64_tr_b16 v[124:125], v13 offset:34816
    ds_read_b64_tr_b16 v[126:127], v13 offset:35328
    v_mfma_f32_32x32x16_bf16 v[64:79], v[200:203], v[104:107], v[64:79]
    v_mfma_f32_32x32x16_bf16 v[80:95], v[200:203], v[108:111], v[80:95]
    s_add_u32 s53, s53, s96
    buffer_load_dword v26, v30, s[16:19], s53 offen
    s_add_u32 s53, s53, s96
    buffer_load_dword v27, v30, s[16:19], s53 offen
    s_waitcnt lgkmcnt(0)
    s_nop 0
    v_mfma_f32_32x32x16_bf16 v[64:79], v[208:211], v[112:115], v[64:79]
    ds_read_b64_tr_b16 v[96:97], v12 offset:3072
    ds_read_b64_tr_b16 v[98:99], v12 offset:3584
    ds_read_b64_tr_b16 v[100:101], v13 offset:3072
    ds_read_b64_tr_b16 v[102:103], v13 offset:3584
    ds_read_b64_tr_b16 v[104:105], v12 offset:35840
    ds_read_b64_tr_b16 v[106:107], v12 offset:36352
    v_mfma_f32_32x32x16_bf16 v[80:95], v[208:211], v[116:119], v[80:95]
    ds_read_b64_tr_b16 v[108:109], v13 offset:35840
    ds_read_b64_tr_b16 v[110:111], v13 offset:36352
    v_mfma_f32_32x32x16_bf16 v[64:79], v[216:219], v[120:123], v[64:79]
    v_mfma_f32_32x32x16_bf16 v[80:95], v[216:219], v[124:127], v[80:95]
    s_sub_u32 s58, s2, 64
    s_cmp_ge_u32 s40, 4
    s_cselect_b32 s58, 128, s58
    s_cmp_ge_u32 s58, 128
    s_cbranch_scc1 NOPD_3
    v_lshrrev_b32 v21, 3, v1
    v_lshlrev_b32_e64 v23, 1, v21
    v_mul_u32_u24 v21, 6144, v21
    v_and_b32_e64 v22, 7, v1
    v_lshl_add_u32 v21, v22, 4, v21
    s_and_b32 s52, s2, 3
    s_and_b32 s53, s40, 3
    s_lshl_b32 s53, s53, 6
    s_lshl_b32 s59, s52, 8
    s_add_u32 s53, s53, s59
    buffer_load_ushort v164, v23, s[24:27], s53 offen offset:0
    buffer_load_ushort v165, v23, s[24:27], s53 offen offset:16
    buffer_load_ushort v166, v23, s[24:27], s53 offen offset:32
    buffer_load_ushort v167, v23, s[24:27], s53 offen offset:48
    s_lshr_b32 s52, s2, 2
    s_lshl_b32 s52, s52, 7
    s_mul_i32 s59, s53, 3072
    s_add_u32 s52, s52, s59
    buffer_load_dwordx4 v[132:135], v21, s[20:23], s52 offen
    s_add_u32 s52, s52, 49152
    buffer_load_dwordx4 v[140:143], v21, s[20:23], s52 offen
    s_add_u32 s52, s52, 49152
    buffer_load_dwordx4 v[148:151], v21, s[20:23], s52 offen
    s_add_u32 s52, s52, 49152
    buffer_load_dwordx4 v[156:159], v21, s[20:23], s52 offen
NOPD_3:
    s_xor_b32 s52, s91, 0
    s_mul_i32 s52, s52, 196608
    s_add_u32 s52, s52, s56
    s_add_u32 m0, s54, 5120
    s_nop 0
    buffer_load_dwordx4 v11, s[8:11], s52 offen lds
    s_waitcnt lgkmcnt(0)
    v_mfma_f32_32x32x16_bf16 v[64:79], v[224:227], v[96:99], v[64:79]
    ds_read_b64_tr_b16 v[112:113], v12 offset:4096
    ds_read_b64_tr_b16 v[114:115], v12 offset:4608
    ds_read_b64_tr_b16 v[116:117], v13 offset:4096
    ds_read_b64_tr_b16 v[118:119], v13 offset:4608
    ds_read_b64_tr_b16 v[120:121], v12 offset:36864
    ds_read_b64_tr_b16 v[122:123], v12 offset:37376
    v_mfma_f32_32x32x16_bf16 v[80:95], v[224:227], v[100:103], v[80:95]
    ds_read_b64_tr_b16 v[124:125], v13 offset:36864
    ds_read_b64_tr_b16 v[126:127], v13 offset:37376
    v_mfma_f32_32x32x16_bf16 v[64:79], v[232:235], v[104:107], v[64:79]
    v_mfma_f32_32x32x16_bf16 v[80:95], v[232:235], v[108:111], v[80:95]
    s_xor_b32 s52, s91, 1
    s_mul_i32 s52, s52, 196608
    s_add_u32 s52, s52, s56
    s_add_u32 m0, s54, 6144
    s_nop 0
    buffer_load_dwordx4 v11, s[8:11], s52 offen lds
    s_xor_b32 s52, s91, 2
    s_mul_i32 s52, s52, 196608
    s_add_u32 s52, s52, s56
    s_add_u32 m0, s54, 7168
    s_nop 0
    buffer_load_dwordx4 v11, s[8:11], s52 offen lds
    s_waitcnt lgkmcnt(0)
    v_mfma_f32_32x32x16_bf16 v[64:79], v[240:243], v[112:115], v[64:79]
    v_mfma_f32_32x32x16_bf16 v[80:95], v[240:243], v[116:119], v[80:95]
    v_mfma_f32_32x32x16_bf16 v[64:79], v[248:251], v[120:123], v[64:79]
    v_mfma_f32_32x32x16_bf16 v[80:95], v[248:251], v[124:127], v[80:95]
    s_xor_b32 s52, s91, 3
    s_mul_i32 s52, s52, 196608
    s_add_u32 s52, s52, s56
    s_add_u32 m0, s54, 8192
    s_nop 0
    buffer_load_dwordx4 v11, s[8:11], s52 offen lds
L_KVDONE:
    s_add_u32 s52, s54, 12288
    v_add_u32_e64 v11, s52, v2
    v_xor_b32 v9, 16384, v11
    s_lshl_b32 s55, s45, 21
    s_lshl_b32 s59, s44, 18
    s_add_u32 s55, s55, s59
    s_lshl_b32 s59, s47, 17
    s_add_u32 s55, s55, s59
    s_lshl_b32 s59, s43, 12
    s_add_u32 s55, s55, s59
    s_lshl_b32 s59, s46, 10
    s_add_u32 s55, s55, s59
    s_add_u32 s55, s55, 6291456
    s_mov_b32 s56, 512
    s_cmp_eq_u32 s45, 0
    s_cselect_b32 s56, 65536, s56
    s_add_u32 s56, s55, s56
    v_and_b32 v21, 1, v8
    v_lshlrev_b32_e64 v21, 16, v21
    v_lshl_add_u32 v21, v20, 8, v21
    v_and_b32_e64 v22, 15, v1
    v_lshl_add_u32 v21, v22, 4, v21
    s_cmp_eq_u32 s45, 0
    s_cselect_b64 s[90:91], -1, 0
    v_cndmask_b32 v21, v21, v2, s[90:91]
    ds_write_b128 v11, v[80:83] offset:0
    ds_write_b128 v11, v[84:87] offset:1024
    ds_write_b128 v11, v[88:91] offset:2048
    ds_write_b128 v11, v[92:95] offset:3072
    s_waitcnt vmcnt(0)
    s_cmp_ge_u32 s2, 224
    s_cbranch_scc1 L_NORL2
    s_mov_b32 s52, 0x05040100
    s_mov_b32 s53, 0x07060302
    v_perm_b32 v56, v17, v16, s52
    v_perm_b32 v57, v19, v18, s52
    v_perm_b32 v58, v25, v24, s52
    v_perm_b32 v59, v27, v26, s52
    v_perm_b32 v60, v17, v16, s53
    v_perm_b32 v61, v19, v18, s53
    v_perm_b32 v62, v25, v24, s53
    v_perm_b32 v63, v27, v26, s53
    s_add_u32 s52, s98, s99
    buffer_store_dwordx4 v[56:59], v2, s[12:15], s98 offen sc1
    buffer_store_dwordx4 v[60:63], v2, s[12:15], s52 offen sc1
L_NORL2:
    s_cmp_ge_u32 s58, 128
    s_cbranch_scc1 L_NOPD2
    s_waitcnt vmcnt(6)
    v_lshlrev_b32 v164, 16, v164
    v_lshlrev_b32 v165, 16, v165
    v_lshlrev_b32 v166, 16, v166
    v_lshlrev_b32_e64 v167, 16, v167
    v_mul_f32 v32, 0xbfb8aa3b, v164
    v_mul_f32 v33, 0xbfb8aa3b, v165
    v_mul_f32 v34, 0xbfb8aa3b, v166
    v_mul_f32 v35, 0xbfb8aa3b, v167
    v_exp_f32 v32, v32
    v_exp_f32 v33, v33
    v_exp_f32 v34, v34
    v_exp_f32 v35, v35
    v_add_f32 v32, 1.0, v32
    v_add_f32 v33, 1.0, v33
    v_add_f32 v34, 1.0, v34
    v_add_f32 v35, 1.0, v35
    v_rcp_f32 v32, v32
    v_rcp_f32 v33, v33
    v_rcp_f32 v34, v34
    v_rcp_f32 v35, v35
    v_mul_f32 v164, v164, v32
    v_mul_f32 v165, v165, v33
    v_mul_f32 v166, v166, v34
    v_mul_f32 v167, v167, v35
    v_cvt_pk_bf16_f32 v164, v164, v164
    v_cvt_pk_bf16_f32 v165, v165, v165
    v_cvt_pk_bf16_f32 v166, v166, v166
    v_cvt_pk_bf16_f32 v167, v167, v167
    v_and_b32 v164, 0xffff0000, v164
    v_and_b32 v165, 0xffff0000, v165
    v_and_b32 v166, 0xffff0000, v166
    v_and_b32 v167, 0xffff0000, v167
    v_and_b32 v48, 7, v1
    v_lshlrev_b32 v48, 5, v48
    v_lshl_add_u32 v48, v8, 3, v48
    s_and_b32 s52, s40, 3
    s_lshl_b32 s52, s52, 8
    s_add_u32 s52, s52, 162560
    v_add_u32_e64 v48, s52, v48
    v_mov_b32 v49, 163584
    v_mov_b32 v50, 1
    s_waitcnt vmcnt(5)
    v_lshlrev_b32_e64 v32, 16, v132
    v_and_b32 v33, 0xffff0000, v132
    v_lshlrev_b32_e64 v34, 16, v133
    v_and_b32 v35, 0xffff0000, v133
    v_lshlrev_b32_e64 v36, 16, v134
    v_and_b32 v37, 0xffff0000, v134
    v_lshlrev_b32_e64 v38, 16, v135
    v_and_b32 v39, 0xffff0000, v135
    v_mul_f32 v40, v32, v164
    v_mul_f32 v41, v33, v164
    v_mul_f32 v42, v34, v164
    v_mul_f32 v43, v35, v164
    v_mul_f32 v44, v36, v164
    v_mul_f32 v45, v37, v164
    v_mul_f32 v46, v38, v164
    v_mul_f32 v47, v39, v164
    s_waitcnt vmcnt(4)
    v_lshlrev_b32 v32, 16, v140
    v_and_b32 v33, 0xffff0000, v140
    v_lshlrev_b32_e64 v34, 16, v141
    v_and_b32 v35, 0xffff0000, v141
    v_lshlrev_b32_e64 v36, 16, v142
    v_and_b32 v37, 0xffff0000, v142
    v_lshlrev_b32_e64 v38, 16, v143
    v_and_b32 v39, 0xffff0000, v143
    v_fmac_f32 v40, v32, v165
    v_fmac_f32 v41, v33, v165
    v_fmac_f32 v42, v34, v165
    v_fmac_f32 v43, v35, v165
    v_fmac_f32 v44, v36, v165
    v_fmac_f32 v45, v37, v165
    v_fmac_f32 v46, v38, v165
    v_fmac_f32 v47, v39, v165
    s_waitcnt vmcnt(3)
    v_lshlrev_b32 v32, 16, v148
    v_and_b32 v33, 0xffff0000, v148
    v_lshlrev_b32_e64 v34, 16, v149
    v_and_b32 v35, 0xffff0000, v149
    v_lshlrev_b32_e64 v36, 16, v150
    v_and_b32 v37, 0xffff0000, v150
    v_lshlrev_b32_e64 v38, 16, v151
    v_and_b32 v39, 0xffff0000, v151
    v_fmac_f32 v40, v32, v166
    v_fmac_f32 v41, v33, v166
    v_fmac_f32 v42, v34, v166
    v_fmac_f32 v43, v35, v166
    v_fmac_f32 v44, v36, v166
    v_fmac_f32 v45, v37, v166
    v_fmac_f32 v46, v38, v166
    v_fmac_f32 v47, v39, v166
    s_waitcnt vmcnt(2)
    v_lshlrev_b32 v32, 16, v156
    v_and_b32 v33, 0xffff0000, v156
    v_lshlrev_b32_e64 v34, 16, v157
    v_and_b32 v35, 0xffff0000, v157
    v_lshlrev_b32_e64 v36, 16, v158
    v_and_b32 v37, 0xffff0000, v158
    v_lshlrev_b32_e64 v38, 16, v159
    v_and_b32 v39, 0xffff0000, v159
    v_fmac_f32 v40, v32, v167
    v_fmac_f32 v41, v33, v167
    v_fmac_f32 v42, v34, v167
    v_fmac_f32 v43, v35, v167
    v_fmac_f32 v44, v36, v167
    v_fmac_f32 v45, v37, v167
    v_fmac_f32 v46, v38, v167
    v_fmac_f32 v47, v39, v167
    v_permlane32_swap_b32 v40, v44
    v_permlane32_swap_b32 v41, v45
    v_permlane32_swap_b32 v42, v46
    v_permlane32_swap_b32 v43, v47
    v_add_f32 v40, v40, v44
    v_add_f32 v41, v41, v45
    v_add_f32 v42, v42, v46
    v_add_f32 v43, v43, v47
    s_nop 0
    v_permlane16_swap_b32 v40, v42
    v_permlane16_swap_b32 v41, v43
    v_add_f32 v40, v40, v42
    v_add_f32 v41, v41, v43
    s_nop 0
    v_add_f32_dpp v40, v40, v40 row_ror:8 row_mask:0xf bank_mask:0xf
    v_add_f32_dpp v41, v41, v41 row_ror:8 row_mask:0xf bank_mask:0xf
    ds_write_b64 v48, v[40:41]
    s_mov_b64 exec, 1
    ds_add_rtn_u32 v50, v49, v50
    s_mov_b64 exec, -1
    v_add_u32 v49, 162560, v2
    v_mov_b32 v48, 0xff
    s_waitcnt lgkmcnt(0)
    v_readfirstlane_b32 s52, v50
    s_nop 0
    s_cmp_lg_u32 s52, 3
    s_cbranch_scc1 L_NOPD2
    s_mov_b64 exec, 0xffff
    ds_read_b128 v[96:99], v49 offset:0
    ds_read_b128 v[100:103], v49 offset:256
    ds_read_b128 v[104:107], v49 offset:512
    ds_read_b128 v[108:111], v49 offset:768
    s_lshl_b32 s52, s2, 8
    s_add_u32 s52, s52, 65536
    s_waitcnt lgkmcnt(0)
    s_nop 0
    v_pk_add_f32 v[96:97], v[96:97], v[100:101]
    v_pk_add_f32 v[104:105], v[104:105], v[108:109]
    v_pk_add_f32 v[98:99], v[98:99], v[102:103]
    v_pk_add_f32 v[106:107], v[106:107], v[110:111]
    v_pk_add_f32 v[96:97], v[96:97], v[104:105]
    v_pk_add_f32 v[98:99], v[98:99], v[106:107]
    s_lshr_b32 s53, s50, 0
    v_add_u32 v96, 0x80, v96
    v_bfi_b32 v96, v48, s53, v96
    s_lshr_b32 s53, s50, 8
    v_add_u32 v97, 0x80, v97
    v_bfi_b32 v97, v48, s53, v97
    s_lshr_b32 s53, s50, 16
    v_add_u32 v98, 0x80, v98
    v_bfi_b32 v98, v48, s53, v98
    s_lshr_b32 s53, s50, 24
    v_add_u32 v99, 0x80, v99
    v_bfi_b32 v99, v48, s53, v99
    buffer_store_dwordx4 v[96:99], v2, s[12:15], s52 offen sc1
    s_mov_b64 exec, -1
L_NOPD2:
    s_waitcnt lgkmcnt(0)
    s_barrier
    ds_read_b128 v[80:83], v9 offset:0
    ds_read_b128 v[84:87], v9 offset:1024
    ds_read_b128 v[88:91], v9 offset:2048
    ds_read_b128 v[92:95], v9 offset:3072
    s_waitcnt lgkmcnt(2)
    v_pk_add_f32 v[64:65], v[64:65], v[80:81]
    v_pk_add_f32 v[66:67], v[66:67], v[82:83]
    v_pk_add_f32 v[68:69], v[68:69], v[84:85]
    v_pk_add_f32 v[70:71], v[70:71], v[86:87]
    v_cvt_pk_bf16_f32 v32, v64, v65
    v_cvt_pk_bf16_f32 v33, v66, v67
    v_cvt_pk_bf16_f32 v34, v68, v69
    v_cvt_pk_bf16_f32 v35, v70, v71
    buffer_store_dwordx4 v[32:35], v21, s[12:15], s55 offen sc1
    s_waitcnt lgkmcnt(0)
    s_nop 0
    v_pk_add_f32 v[72:73], v[72:73], v[88:89]
    v_pk_add_f32 v[74:75], v[74:75], v[90:91]
    v_pk_add_f32 v[76:77], v[76:77], v[92:93]
    v_pk_add_f32 v[78:79], v[78:79], v[94:95]
    v_cvt_pk_bf16_f32 v36, v72, v73
    v_cvt_pk_bf16_f32 v37, v74, v75
    v_cvt_pk_bf16_f32 v38, v76, v77
    v_cvt_pk_bf16_f32 v39, v78, v79
    buffer_store_dwordx4 v[36:39], v21, s[12:15], s56 offen sc1
    ds_read_b64_tr_b16 v[112:113], v10 offset:5120
    ds_read_b64_tr_b16 v[114:115], v10 offset:5376
    ds_read_b64_tr_b16 v[116:117], v10 offset:21504
    ds_read_b64_tr_b16 v[118:119], v10 offset:21760
    ds_read_b64_tr_b16 v[120:121], v10 offset:37888
    ds_read_b64_tr_b16 v[122:123], v10 offset:38144
    ds_read_b64_tr_b16 v[124:125], v10 offset:54272
    ds_read_b64_tr_b16 v[126:127], v10 offset:54528
    s_waitcnt lgkmcnt(6)
    v_mfma_f32_32x32x16_bf16 v[96:111], v[112:115], v[128:131], 0
    ds_read_b64_tr_b16 v[112:113], v10 offset:6144
    ds_read_b64_tr_b16 v[114:115], v10 offset:6400
    s_waitcnt lgkmcnt(6)
    v_mfma_f32_32x32x16_bf16 v[96:111], v[116:119], v[136:139], v[96:111]
    ds_read_b64_tr_b16 v[116:117], v10 offset:22528
    ds_read_b64_tr_b16 v[118:119], v10 offset:22784
    s_waitcnt lgkmcnt(6)
    v_mfma_f32_32x32x16_bf16 v[96:111], v[120:123], v[144:147], v[96:111]
    ds_read_b64_tr_b16 v[120:121], v10 offset:38912
    ds_read_b64_tr_b16 v[122:123], v10 offset:39168
    s_waitcnt lgkmcnt(6)
    v_mfma_f32_32x32x16_bf16 v[96:111], v[124:127], v[152:155], v[96:111]
    ds_read_b64_tr_b16 v[124:125], v10 offset:55296
    ds_read_b64_tr_b16 v[126:127], v10 offset:55552
    s_waitcnt lgkmcnt(6)
    v_mfma_f32_32x32x16_bf16 v[96:111], v[112:115], v[160:163], v[96:111]
    ds_read_b64_tr_b16 v[112:113], v10 offset:7168
    ds_read_b64_tr_b16 v[114:115], v10 offset:7424
    s_waitcnt lgkmcnt(6)
    v_mfma_f32_32x32x16_bf16 v[96:111], v[116:119], v[168:171], v[96:111]
    ds_read_b64_tr_b16 v[116:117], v10 offset:23552
    ds_read_b64_tr_b16 v[118:119], v10 offset:23808
    s_waitcnt lgkmcnt(6)
    v_mfma_f32_32x32x16_bf16 v[96:111], v[120:123], v[176:179], v[96:111]
    ds_read_b64_tr_b16 v[120:121], v10 offset:39936
    ds_read_b64_tr_b16 v[122:123], v10 offset:40192
    s_waitcnt lgkmcnt(6)
    v_mfma_f32_32x32x16_bf16 v[96:111], v[124:127], v[184:187], v[96:111]
    ds_read_b64_tr_b16 v[124:125], v10 offset:56320
    ds_read_b64_tr_b16 v[126:127], v10 offset:56576
    s_waitcnt lgkmcnt(6)
    v_mfma_f32_32x32x16_bf16 v[96:111], v[112:115], v[192:195], v[96:111]
    ds_read_b64_tr_b16 v[112:113], v10 offset:8192
    ds_read_b64_tr_b16 v[114:115], v10 offset:8448
    s_waitcnt lgkmcnt(6)
    v_mfma_f32_32x32x16_bf16 v[96:111], v[116:119], v[200:203], v[96:111]
    ds_read_b64_tr_b16 v[116:117], v10 offset:24576
    ds_read_b64_tr_b16 v[118:119], v10 offset:24832
    s_waitcnt lgkmcnt(6)
    v_mfma_f32_32x32x16_bf16 v[96:111], v[120:123], v[208:211], v[96:111]
    s_waitcnt vmcnt(0)
    s_barrier
    s_cmp_lg_u32 s40, 0
    s_cbranch_scc1 NOFL_4
    s_lshl_b32 s52, s44, 12
    s_lshl_b32 s59, s43, 8
    s_add_u32 s52, s52, s59
    s_lshl_b32 s59, s45, 7
    s_add_u32 s52, s52, s59
    s_add_u32 s52, s52, 8192
    v_mov_b32 v22, s50
    s_mov_b64 exec, 1
    buffer_store_dword v22, v2, s[12:15], s52 offen sc1
    s_mov_b64 exec, -1
NOFL_4:
    s_cmp_lg_u32 s40, 2
    s_cbranch_scc1 NOFL_5
    s_lshl_b32 s52, s2, 7
    s_add_u32 s52, s52, 393216
    v_mov_b32 v22, s50
    s_mov_b64 exec, 1
    buffer_store_dword v22, v2, s[12:15], s52 offen sc1
    s_mov_b64 exec, -1
NOFL_5:
    ds_read_b64_tr_b16 v[120:121], v10 offset:40960
    ds_read_b64_tr_b16 v[122:123], v10 offset:41216
    s_waitcnt lgkmcnt(6)
    v_mfma_f32_32x32x16_bf16 v[96:111], v[124:127], v[216:219], v[96:111]
    ds_read_b64_tr_b16 v[124:125], v10 offset:57344
    ds_read_b64_tr_b16 v[126:127], v10 offset:57600
    s_waitcnt lgkmcnt(6)
    v_mfma_f32_32x32x16_bf16 v[96:111], v[112:115], v[224:227], v[96:111]
    s_waitcnt lgkmcnt(4)
    v_mfma_f32_32x32x16_bf16 v[96:111], v[116:119], v[232:235], v[96:111]
    s_waitcnt lgkmcnt(2)
    v_mfma_f32_32x32x16_bf16 v[96:111], v[120:123], v[240:243], v[96:111]
    s_waitcnt lgkmcnt(0)
    v_mfma_f32_32x32x16_bf16 v[96:111], v[124:127], v[248:251], v[96:111]
    s_lshl_b32 s52, s40, 11
    s_add_u32 s52, s52, 131072
    v_add_u32 v11, s52, v2
    v_xor_b32 v9, 2048, v11
    v_mov_b32 v22, 0x3eb8aa3b
    s_nop 6
    ds_write_b128 v11, v[104:107] offset:0
    ds_write_b128 v11, v[108:111] offset:1024
    s_waitcnt lgkmcnt(0)
    s_barrier
    ds_read_b128 v[104:107], v9 offset:0
    ds_read_b128 v[108:111], v9 offset:1024
    s_waitcnt lgkmcnt(0)
    v_pk_add_f32 v[96:97], v[96:97], v[104:105]
    v_pk_add_f32 v[98:99], v[98:99], v[106:107]
    v_pk_add_f32 v[100:101], v[100:101], v[108:109]
    v_pk_add_f32 v[102:103], v[102:103], v[110:111]
    v_pk_mul_f32 v[96:97], v[96:97], v[22:23] op_sel_hi:[1,0]
    v_pk_mul_f32 v[98:99], v[98:99], v[22:23] op_sel_hi:[1,0]
    v_pk_mul_f32 v[100:101], v[100:101], v[22:23] op_sel_hi:[1,0]
    v_pk_mul_f32 v[102:103], v[102:103], v[22:23] op_sel_hi:[1,0]
    v_cvt_pk_bf16_f32 v4, v96, v97
    v_cvt_pk_bf16_f32 v5, v98, v99
    v_cvt_pk_bf16_f32 v6, v100, v101
    v_cvt_pk_bf16_f32 v7, v102, v103
    v_lshrrev_b32 v24, 3, v1
    v_and_b32 v25, 7, v1
    v_and_b32 v31, 1, v8
    v_lshlrev_b32 v31, 2, v31
    v_xor_b32 v31, v31, v25
    v_lshlrev_b32 v31, 4, v31
    v_lshl_add_u32 v31, v24, 10, v31
    s_lshl_b32 s53, s40, 16
    s_lshl_b32 s59, s49, 7
    s_add_u32 s53, s53, s59
    s_lshl_b32 s54, s40, 13
    s_add_u32 s54, s54, 65536
    s_add_u32 m0, s54, 0
    s_add_u32 s56, s53, 0
    buffer_load_dwordx4 v31, s[92:95], s56 offen lds
    s_add_u32 m0, s54, 1024
    s_add_u32 s56, s53, 8192
    buffer_load_dwordx4 v31, s[92:95], s56 offen lds
    s_add_u32 m0, s54, 2048
    s_add_u32 s56, s53, 16384
    buffer_load_dwordx4 v31, s[92:95], s56 offen lds
    s_add_u32 m0, s54, 3072
    s_add_u32 s56, s53, 24576
    buffer_load_dwordx4 v31, s[92:95], s56 offen lds
    s_add_u32 m0, s54, 4096
    s_add_u32 s56, s53, 32768
    buffer_load_dwordx4 v31, s[92:95], s56 offen lds
    s_add_u32 m0, s54, 5120
    s_add_u32 s56, s53, 40960
    buffer_load_dwordx4 v31, s[92:95], s56 offen lds
    s_add_u32 m0, s54, 6144
    s_add_u32 s56, s53, 49152
    buffer_load_dwordx4 v31, s[92:95], s56 offen lds
    s_add_u32 m0, s54, 7168
    s_add_u32 s56, s53, 57344
    buffer_load_dwordx4 v31, s[92:95], s56 offen lds
    v_and_b32 v9, 31, v1
    v_lshlrev_b32 v10, 2, v20
    v_sub_u32_e64 v9, v9, v10
    v_cmp_gt_i32 s[64:65], 0, v9
    v_cmp_gt_i32 s[66:67], 1, v9
    v_cmp_gt_i32 s[68:69], 2, v9
    v_cmp_gt_i32 s[70:71], 3, v9
    v_cmp_gt_i32 s[72:73], 8, v9
    v_cmp_gt_i32 s[74:75], 9, v9
    v_cmp_gt_i32 s[76:77], 10, v9
    v_cmp_gt_i32 s[78:79], 11, v9
    v_cmp_gt_i32 s[80:81], 16, v9
    v_cmp_gt_i32 s[82:83], 17, v9
    v_cmp_gt_i32 s[84:85], 18, v9
    v_cmp_gt_i32 s[86:87], 19, v9
    v_cmp_gt_i32 s[88:89], 24, v9
    v_cmp_gt_i32 s[90:91], 25, v9
    v_cmp_gt_i32_e64 vcc, 26, v9
    v_cmp_gt_i32 s[0:1], 27, v9
    v_mov_b32 v112, 0x3f803f80
    v_mov_b32 v113, 0x3f803f80
    v_mov_b32 v114, 0x3f803f80
    v_mov_b32 v115, 0x3f803f80
    v_mov_b32 v116, 0x3f803f80
    v_mov_b32 v117, 0x3f803f80
    v_mov_b32 v118, 0x3f803f80
    v_mov_b32 v119, 0x3f803f80
    v_mov_b32 v120, 0x3f803f80
    v_mov_b32 v121, 0x3f803f80
    v_mov_b32 v122, 0x3f803f80
    v_mov_b32 v123, 0x3f803f80
    v_mov_b32 v124, 0x3f803f80
    v_mov_b32 v125, 0x3f803f80
    v_mov_b32 v126, 0x3f803f80
    v_mov_b32 v127, 0x3f803f80
    s_mul_i32 s52, s47, 12288
    s_lshl_b32 s59, s46, 10
    s_add_u32 s52, s52, s59
    v_add_u32 v9, s52, v2
    v_and_b32 v10, 15, v1
    v_lshlrev_b32_e64 v10, 4, v10
    v_lshl_add_u32 v10, v20, 8, v10
    s_add_u32 s52, s52, 24576
    v_add_u32_e64 v10, s52, v10
    v_mov_b32 v13, 0xf149f2ca
    v_mov_b32_e64 v14, 0
    v_mov_b32 v11, 0xffff
    v_mov_b32 v12, 0xffff0000
    v_cndmask_b32_e64 v32, v14, v13, s[64:65]
    v_cndmask_b32_e64 v33, v14, v13, s[66:67]
    v_cndmask_b32_e64 v34, v14, v13, s[68:69]
    v_cndmask_b32_e64 v35, v14, v13, s[70:71]
    v_cndmask_b32_e64 v36, v14, v13, s[72:73]
    v_cndmask_b32_e64 v37, v14, v13, s[74:75]
    v_cndmask_b32_e64 v38, v14, v13, s[76:77]
    v_cndmask_b32_e64 v39, v14, v13, s[78:79]
    v_cndmask_b32_e64 v40, v14, v13, s[80:81]
    v_cndmask_b32_e64 v41, v14, v13, s[82:83]
    v_cndmask_b32_e64 v42, v14, v13, s[84:85]
    v_cndmask_b32_e64 v43, v14, v13, s[86:87]
    v_cndmask_b32_e64 v44, v14, v13, s[88:89]
    v_cndmask_b32_e64 v45, v14, v13, s[90:91]
    v_cndmask_b32_e64 v46, v14, v13, vcc
    v_cndmask_b32_e64 v47, v14, v13, s[0:1]
    v_cndmask_b32_e64 v80, v13, v14, s[64:65]
    v_cndmask_b32_e64 v81, v13, v14, s[66:67]
    v_cndmask_b32_e64 v82, v13, v14, s[68:69]
    v_cndmask_b32_e64 v83, v13, v14, s[70:71]
    v_cndmask_b32_e64 v84, v13, v14, s[72:73]
    v_cndmask_b32_e64 v85, v13, v14, s[74:75]
    v_cndmask_b32_e64 v86, v13, v14, s[76:77]
    v_cndmask_b32_e64 v87, v13, v14, s[78:79]
    v_cndmask_b32_e64 v88, v13, v14, s[80:81]
    v_cndmask_b32_e64 v89, v13, v14, s[82:83]
    v_cndmask_b32_e64 v90, v13, v14, s[84:85]
    v_cndmask_b32_e64 v91, v13, v14, s[86:87]
    v_cndmask_b32_e64 v92, v13, v14, s[88:89]
    v_cndmask_b32_e64 v93, v13, v14, s[90:91]
    v_cndmask_b32_e64 v94, v13, v14, vcc
    v_cndmask_b32_e64 v95, v13, v14, s[0:1]
    v_cndmask_b32_e64 v16, v14, v11, s[64:65]
    v_cndmask_b32_e64 v15, v14, v12, s[66:67]
    v_or_b32_e64 v16, v16, v15
    v_cndmask_b32_e64 v17, v14, v11, s[68:69]
    v_cndmask_b32_e64 v15, v14, v12, s[70:71]
    v_or_b32_e64 v17, v17, v15
    v_cndmask_b32_e64 v18, v14, v11, s[72:73]
    v_cndmask_b32_e64 v15, v14, v12, s[74:75]
    v_or_b32_e64 v18, v18, v15
    v_cndmask_b32_e64 v19, v14, v11, s[76:77]
    v_cndmask_b32_e64 v15, v14, v12, s[78:79]
    v_or_b32_e64 v19, v19, v15
    v_cndmask_b32_e64 v20, v14, v11, s[80:81]
    v_cndmask_b32_e64 v15, v14, v12, s[82:83]
    v_or_b32_e64 v20, v20, v15
    v_cndmask_b32_e64 v21, v14, v11, s[84:85]
    v_cndmask_b32_e64 v15, v14, v12, s[86:87]
    v_or_b32_e64 v21, v21, v15
    v_cndmask_b32_e64 v22, v14, v11, s[88:89]
    v_cndmask_b32_e64 v15, v14, v12, s[90:91]
    v_or_b32_e64 v22, v22, v15
    v_cndmask_b32_e64 v23, v14, v11, vcc
    v_cndmask_b32_e64 v15, v14, v12, s[0:1]
    v_or_b32 v23, v23, v15
    s_lshl_b32 s98, s43, 17
    s_lshl_b32 s59, s46, 15
    s_add_u32 s98, s98, s59
    s_lshl_b32 s59, s44, 12
    s_add_u32 s98, s98, s59
    s_lshl_b32 s59, s45, 11
    s_add_u32 s98, s98, s59
    s_lshl_b32 s59, s47, 10
    s_add_u32 s98, s98, s59
    s_add_u32 s98, s98, 10485760
    s_cmp_eq_u32 s40, 1
    s_cbranch_scc0 L_NOPREPL
    s_mul_i32 s56, s49, 7
    v_lshrrev_b32 v152, 5, v1
    v_add_u32 v152, s56, v152
    v_and_b32 v153, 1, v152
    v_lshrrev_b32 v152, 1, v152
    v_lshlrev_b32 v152, 7, v152
    v_lshl_add_u32 v152, v153, 1, v152
    v_and_b32_e64 v153, 31, v1
    v_lshl_add_u32 v152, v153, 2, v152
    buffer_load_ushort v155, v152, s[28:31], 0 offen offset:0
    buffer_load_ushort v156, v152, s[28:31], 0 offen offset:128
    buffer_load_ushort v157, v152, s[28:31], 0 offen offset:256
    buffer_load_ushort v158, v152, s[28:31], 0 offen offset:384
    v_lshlrev_b32 v153, 1, v1
    s_lshl_b32 s55, s49, 7
    buffer_load_ushort v154, v153, s[32:35], s55 offen
    v_lshrrev_b32 v148, 4, v1
    v_lshlrev_b32 v149, 13, v148
    v_and_b32_e64 v150, 15, v1
    v_lshl_add_u32 v149, v150, 4, v149
    s_lshl_b32 s58, s49, 10
    s_add_u32 s58, s58, 81920
    buffer_load_dwordx4 v[128:131], v149, s[12:15], s58 offen offset:0 sc1
    buffer_load_dwordx4 v[132:135], v149, s[12:15], s58 offen offset:256 sc1
    buffer_load_dwordx4 v[136:139], v149, s[12:15], s58 offen offset:512 sc1
    buffer_load_dwordx4 v[140:143], v149, s[12:15], s58 offen offset:768 sc1
L_NOPREPL:
    s_cmp_eq_u32 s40, 2
    s_cbranch_scc0 L_NOPREPM
    v_lshrrev_b32 v148, 5, v1
    v_sub_u32 v149, 1, v148
    v_lshlrev_b32 v149, 13, v149
    v_bfe_u32 v150, v1, 4, 1
    v_lshl_add_u32 v149, v150, 10, v149
    v_and_b32_e64 v150, 15, v1
    v_lshl_add_u32 v149, v150, 4, v149
    s_lshl_b32 s58, s48, 11
    s_add_u32 s58, s58, 90112
    buffer_load_dwordx4 v[128:131], v149, s[12:15], s58 offen offset:0 sc1
    buffer_load_dwordx4 v[132:135], v149, s[12:15], s58 offen offset:256 sc1
    buffer_load_dwordx4 v[136:139], v149, s[12:15], s58 offen offset:512 sc1
    buffer_load_dwordx4 v[140:143], v149, s[12:15], s58 offen offset:768 sc1
L_NOPREPM:
    s_lshr_b32 s53, s40, 2
    s_and_b32 s54, s40, 3
    s_lshl_b32 s55, s44, 18
    s_lshl_b32 s59, s45, 17
    s_add_u32 s55, s55, s59
    s_lshl_b32 s59, s53, 16
    s_add_u32 s55, s55, s59
    s_lshl_b32 s59, s43, 12
    s_add_u32 s55, s55, s59
    s_mul_i32 s59, s54, 3072
    s_add_u32 s55, s55, s59
    s_add_u32 s55, s55, 6283264
    s_lshl_b32 s54, s54, 3
    s_lshr_b32 s56, 0x303c0f03, s54
    s_mov_b32 s53, 0x3f
    s_cmp_eq_u32 s43, 1
    s_cselect_b32 s53, 0x3c, s53
    s_cmp_eq_u32 s43, 0
    s_cselect_b32 s53, 0x30, s53
    s_and_b32 s56, s56, s53
    s_lshl_b32 s52, s44, 12
    s_lshl_b32 s59, s43, 8
    s_add_u32 s52, s52, s59
    s_add_u32 s52, s52, 7680
    v_lshlrev_b32 v25, 7, v1
    s_mul_i32 s54, s40, 3072
    s_add_u32 s53, s55, 2097152
    s_mov_b32 m0, s54
    s_mov_b32 s101, 0
    s_mov_b32 exec_lo, s56
    s_mov_b32 exec_hi, 0
    s_cbranch_execz L_KVX
L_KVP:
    buffer_load_dword v26, v25, s[12:15], s52 offen sc1
    s_add_u32 s101, s101, 1
    s_cmp_gt_u32 s101, 131072
    s_cbranch_scc1 L_KVX
    s_waitcnt vmcnt(0)
    v_cmp_ne_u32 vcc, s50, v26
    s_nop 0
    s_cbranch_vccnz L_KVP
L_KVX:
    s_mov_b64 exec, -1
    buffer_load_dwordx4 v2, s[12:15], s55 offen offset:0 sc1 lds
    buffer_load_dwordx4 v2, s[12:15], s55 offen offset:1024 sc1 lds
    buffer_load_dwordx4 v2, s[12:15], s55 offen offset:2048 sc1 lds
    s_barrier
    s_add_u32 m0, s54, 24576
    s_nop 0
    buffer_load_dwordx4 v2, s[12:15], s53 offen offset:0 sc1 lds
    buffer_load_dwordx4 v2, s[12:15], s53 offen offset:1024 sc1 lds
    buffer_load_dwordx4 v2, s[12:15], s53 offen offset:2048 sc1 lds
    s_cmp_eq_u32 s40, 2
    s_cselect_b32 s68, 3, 0
    s_cbranch_scc0 L_NOPREP3
    s_mov_b32 s101, 0
    s_mov_b32 s56, 0x0c0c0400
    s_mov_b32 s57, 0x04000c0c
    s_waitcnt vmcnt(6)
    s_nop 0
    v_perm_b32 v144, v129, v128, s56
    v_perm_b32 v145, v131, v130, s57
    v_bitop3_b32 v146, v144, v145, s50 bitop3:0x56
    v_perm_b32 v144, v133, v132, s56
    v_perm_b32 v145, v135, v134, s57
    v_bitop3_b32 v144, v144, v145, s50 bitop3:0x56
    v_or_b32_e64 v146, v146, v144
    v_perm_b32 v144, v137, v136, s56
    v_perm_b32 v145, v139, v138, s57
    v_bitop3_b32 v144, v144, v145, s50 bitop3:0x56
    v_or_b32_e64 v146, v146, v144
    v_perm_b32 v144, v141, v140, s56
    v_perm_b32 v145, v143, v142, s57
    v_bitop3_b32 v144, v144, v145, s50 bitop3:0x56
    v_or_b32 v146, v146, v144
    v_cmp_ne_u32 vcc, 0, v146
    s_nop 0
    s_cbranch_vccnz L_NOPREP2
L_P3EK:
    v_mov_b32 v144, 0xffffff00
    v_and_b32 v128, v144, v128
    v_and_b32 v129, v144, v129
    v_and_b32 v130, v144, v130
    v_and_b32 v131, v144, v131
    v_and_b32 v132, v144, v132
    v_and_b32 v133, v144, v133
    v_and_b32 v134, v144, v134
    v_and_b32 v135, v144, v135
    v_and_b32 v136, v144, v136
    v_and_b32 v137, v144, v137
    v_and_b32 v138, v144, v138
    v_and_b32 v139, v144, v139
    v_and_b32 v140, v144, v140
    v_and_b32 v141, v144, v141
    v_and_b32 v142, v144, v142
    v_and_b32 v143, v144, v143
    v_pk_add_f32 v[128:129], v[128:129], v[132:133]
    v_pk_add_f32 v[136:137], v[136:137], v[140:141]
    v_pk_add_f32 v[130:131], v[130:131], v[134:135]
    v_pk_add_f32 v[138:139], v[138:139], v[142:143]
    v_pk_add_f32 v[128:129], v[128:129], v[136:137]
    v_pk_add_f32 v[130:131], v[130:131], v[138:139]
    v_cvt_pk_bf16_f32 v132, v128, v129
    v_lshlrev_b32_e64 v128, 16, v132
    v_and_b32 v129, 0xffff0000, v132
    v_cvt_pk_bf16_f32 v134, v130, v131
    v_lshlrev_b32_e64 v130, 16, v134
    v_and_b32 v131, 0xffff0000, v134
    v_sub_u32 v148, 1, v148
    v_cvt_f32_u32 v148, v148
    v_add_f32 v128, v148, v128
    v_add_f32 v129, v148, v129
    v_add_f32 v130, v148, v130
    v_add_f32 v131, v148, v131
    v_cvt_pk_bf16_f32 v132, v128, v129
    v_cvt_pk_bf16_f32 v133, v130, v131
    v_lshlrev_b32_e64 v149, 3, v1
    v_add_u32 v149, 162048, v149
    ds_write_b64 v149, v[132:133]
    v_lshlrev_b32_e64 v150, 2, v1
    v_add_u32 v150, 162560, v150
    v_mov_b32 v134, 0x3f803f80
    ds_write_b32 v150, v134
    s_waitcnt lgkmcnt(0)
    s_mov_b32 s68, 0
L_NOPREP3:
    s_cmp_eq_u32 s40, 1
    s_cbranch_scc0 L_NOPREP2
    s_mov_b32 s68, 1
    s_mov_b32 s101, 0
    s_mov_b32 s56, 0x0c0c0400
    s_mov_b32 s57, 0x04000c0c
    s_waitcnt vmcnt(6)
    s_nop 0
    v_perm_b32 v144, v129, v128, s56
    v_perm_b32 v145, v131, v130, s57
    v_bitop3_b32 v146, v144, v145, s50 bitop3:0x56
    v_perm_b32 v144, v133, v132, s56
    v_perm_b32 v145, v135, v134, s57
    v_bitop3_b32 v144, v144, v145, s50 bitop3:0x56
    v_or_b32_e64 v146, v146, v144
    v_perm_b32 v144, v137, v136, s56
    v_perm_b32 v145, v139, v138, s57
    v_bitop3_b32 v144, v144, v145, s50 bitop3:0x56
    v_or_b32_e64 v146, v146, v144
    v_perm_b32 v144, v141, v140, s56
    v_perm_b32 v145, v143, v142, s57
    v_bitop3_b32 v144, v144, v145, s50 bitop3:0x56
    v_or_b32 v146, v146, v144
    v_cmp_ne_u32 vcc, 0, v146
    s_nop 0
    s_cbranch_vccnz L_NOPREP2
L_PRPK:
    v_mov_b32 v144, 0xffffff00
    v_and_b32 v128, v144, v128
    v_and_b32 v129, v144, v129
    v_and_b32 v130, v144, v130
    v_and_b32 v131, v144, v131
    v_and_b32 v132, v144, v132
    v_and_b32 v133, v144, v133
    v_and_b32 v134, v144, v134
    v_and_b32 v135, v144, v135
    v_and_b32 v136, v144, v136
    v_and_b32 v137, v144, v137
    v_and_b32 v138, v144, v138
    v_and_b32 v139, v144, v139
    v_and_b32 v140, v144, v140
    v_and_b32 v141, v144, v141
    v_and_b32 v142, v144, v142
    v_and_b32 v143, v144, v143
    v_pk_add_f32 v[128:129], v[128:129], v[132:133]
    v_pk_add_f32 v[136:137], v[136:137], v[140:141]
    v_pk_add_f32 v[130:131], v[130:131], v[134:135]
    v_pk_add_f32 v[138:139], v[138:139], v[142:143]
    v_pk_add_f32 v[128:129], v[128:129], v[136:137]
    v_pk_add_f32 v[130:131], v[130:131], v[138:139]
    v_cvt_pk_bf16_f32 v132, v128, v129
    v_lshlrev_b32_e64 v128, 16, v132
    v_and_b32 v129, 0xffff0000, v132
    v_cvt_pk_bf16_f32 v134, v130, v131
    v_lshlrev_b32_e64 v130, 16, v134
    v_and_b32 v131, 0xffff0000, v134
    v_cmp_eq_u32 s[90:91], 2, v148
    s_nop 1
    v_cndmask_b32 v148, 0, 1.0, s[90:91]
    v_add_f32 v128, v148, v128
    v_add_f32 v129, v148, v129
    v_add_f32 v130, v148, v130
    v_add_f32_e64 v131, v148, v131
    v_cvt_pk_bf16_f32 v132, v128, v129
    v_lshlrev_b32_e64 v128, 16, v132
    v_and_b32 v129, 0xffff0000, v132
    v_cvt_pk_bf16_f32 v134, v130, v131
    v_lshlrev_b32_e64 v130, 16, v134
    v_and_b32 v131, 0xffff0000, v134
    v_add_u32 v149, 159744, v2
    ds_write_b128 v149, v[128:131]
    v_lshlrev_b32_e64 v152, 2, v1
    v_add_u32 v152, 159744, v152
    ds_read_b32 v136, v152 offset:512
    ds_read_b32 v140, v152 offset:256
    v_lshlrev_b32_e64 v154, 16, v154
    ds_write_b32 v152, v154 offset:1024
    v_lshlrev_b32_e64 v155, 16, v155
    ds_write_b32 v152, v155 offset:1280
    v_lshlrev_b32_e64 v156, 16, v156
    ds_write_b32 v152, v156 offset:1536
    v_lshlrev_b32_e64 v157, 16, v157
    ds_write_b32 v152, v157 offset:1792
    v_lshlrev_b32_e64 v158, 16, v158
    ds_write_b32 v152, v158 offset:2048
    s_waitcnt lgkmcnt(0)
    v_mul_f32 v137, v136, v136
    v_mul_f32 v138, v136, v140
    v_mul_f32 v141, v140, v140
    v_add_f32_dpp v136, v136, v136 quad_perm:[1,0,3,2] row_mask:0xf bank_mask:0xf
    v_add_f32_dpp v137, v137, v137 quad_perm:[1,0,3,2] row_mask:0xf bank_mask:0xf
    v_add_f32_dpp v138, v138, v138 quad_perm:[1,0,3,2] row_mask:0xf bank_mask:0xf
    v_add_f32_dpp v140, v140, v140 quad_perm:[1,0,3,2] row_mask:0xf bank_mask:0xf
    v_add_f32_dpp v141, v141, v141 quad_perm:[1,0,3,2] row_mask:0xf bank_mask:0xf
    v_add_f32_dpp v136, v136, v136 quad_perm:[2,3,0,1] row_mask:0xf bank_mask:0xf
    v_add_f32_dpp v137, v137, v137 quad_perm:[2,3,0,1] row_mask:0xf bank_mask:0xf
    v_add_f32_dpp v138, v138, v138 quad_perm:[2,3,0,1] row_mask:0xf bank_mask:0xf
    v_add_f32_dpp v140, v140, v140 quad_perm:[2,3,0,1] row_mask:0xf bank_mask:0xf
    v_add_f32_dpp v141, v141, v141 quad_perm:[2,3,0,1] row_mask:0xf bank_mask:0xf
    v_add_f32_dpp v136, v136, v136 row_ror:4 row_mask:0xf bank_mask:0xf
    v_add_f32_dpp v137, v137, v137 row_ror:4 row_mask:0xf bank_mask:0xf
    v_add_f32_dpp v138, v138, v138 row_ror:4 row_mask:0xf bank_mask:0xf
    v_add_f32_dpp v140, v140, v140 row_ror:4 row_mask:0xf bank_mask:0xf
    v_add_f32_dpp v141, v141, v141 row_ror:4 row_mask:0xf bank_mask:0xf
    v_add_f32_dpp v136, v136, v136 row_ror:8 row_mask:0xf bank_mask:0xf
    v_add_f32_dpp v137, v137, v137 row_ror:8 row_mask:0xf bank_mask:0xf
    v_add_f32_dpp v138, v138, v138 row_ror:8 row_mask:0xf bank_mask:0xf
    v_add_f32_dpp v140, v140, v140 row_ror:8 row_mask:0xf bank_mask:0xf
    v_add_f32_dpp v141, v141, v141 row_ror:8 row_mask:0xf bank_mask:0xf
    v_mov_b32 v144, v136
    v_mov_b32 v145, v137
    v_mov_b32 v146, v138
    v_mov_b32 v148, v140
    v_mov_b32 v149, v141
    v_permlane16_swap_b32 v136, v144
    v_permlane16_swap_b32 v137, v145
    v_permlane16_swap_b32 v138, v146
    v_permlane16_swap_b32 v140, v148
    v_permlane16_swap_b32 v141, v149
    v_add_f32 v136, v136, v144
    v_add_f32 v137, v137, v145
    v_add_f32 v138, v138, v146
    v_add_f32 v140, v140, v148
    v_add_f32 v141, v141, v149
    v_mov_b32 v144, v136
    v_mov_b32 v145, v137
    v_mov_b32 v146, v138
    v_mov_b32 v148, v140
    v_mov_b32 v149, v141
    v_permlane32_swap_b32 v136, v144
    v_permlane32_swap_b32 v137, v145
    v_permlane32_swap_b32 v138, v146
    v_permlane32_swap_b32 v140, v148
    v_permlane32_swap_b32 v141, v149
    v_add_f32 v136, v136, v144
    v_add_f32 v137, v137, v145
    v_add_f32 v138, v138, v146
    v_add_f32 v140, v140, v148
    v_add_f32 v141, v141, v149
    v_mov_b32 v139, s50
    v_mov_b32 v143, s50
    v_mov_b32 v142, 0
    s_mov_b32 s68, 2
L_NOPREP2:
    s_lshl_b32 s52, s43, 2
    s_add_u32 s52, s52, s46
    s_min_u32 s52, s52, 8
    s_sub_u32 s58, 8, s52
    s_mul_i32 s55, s49, 229376
    s_lshl_b32 s59, s40, 15
    s_add_u32 s55, s55, s59
    s_add_u32 s55, s55, 2097152
    s_mul_i32 s96, s49, 229376
    s_mul_i32 s59, s40, 28672
    s_add_u32 s96, s96, s59
    s_add_u32 s96, s96, 4194304
    s_cmp_eq_u32 s40, 7
    s_cselect_b32 s70, s96, s55
    s_mov_b32 s78, s96
    s_add_u32 s71, s70, 4096
    s_add_u32 s72, s70, 8192
    s_add_u32 s73, s70, 12288
    s_add_u32 s74, s70, 16384
    s_add_u32 s75, s70, 20480
    s_add_u32 s76, s70, 24576
    s_add_u32 s77, s70, 28672
    s_add_u32 s79, s78, 4096
    s_add_u32 s80, s78, 8192
    s_add_u32 s81, s78, 12288
    s_add_u32 s82, s78, 16384
    s_add_u32 s83, s78, 20480
    s_add_u32 s84, s78, 24576
    s_mul_i32 s52, s49, 7
    s_lshr_b32 s52, s52, 1
    s_lshl_b32 s52, s52, 9
    s_add_u32 s52, s52, 393216
    s_mul_i32 s53, s49, 1792
    s_add_u32 s53, s53, 405504
    s_lshl_b32 s57, s41, 7
    s_add_u32 s57, s57, 3968
    v_mov_b32 v27, s52
    v_mov_b32 v25, s53
    v_cmp_gt_u32 s[90:91], 16, v1
    s_nop 1
    v_cndmask_b32 v27, v25, v27, s[90:91]
    v_min_u32 v25, 29, v1
    v_lshl_add_u32 v27, v25, 7, v27
    v_lshlrev_b32 v25, 2, v1
    v_add_u32 v25, s57, v25
    v_cmp_gt_u32 s[90:91], 32, v1
    s_nop 1
    v_cndmask_b32 v27, v25, v27, s[90:91]
    buffer_load_dword v24, v27, s[12:15], 0 offen sc1
    s_waitcnt vmcnt(4)
    s_barrier
    ds_read_b128 v[96:99], v9 offset:8192
    ds_read_b128 v[108:111], v9 offset:7168
    ds_read_b128 v[104:107], v9 offset:6144
    ds_read_b128 v[100:103], v9 offset:5120
    v_mov_b32 v11, v13
    v_mov_b32 v12, v13
    s_waitcnt lgkmcnt(3)
    v_mfma_f32_32x32x16_bf16 v[32:47], v[96:99], v[4:7], v[32:47]
    s_waitcnt lgkmcnt(2)
    v_mfma_f32_32x32x16_bf16 v[48:63], v[108:111], v[4:7], 0
    ds_read_b128 v[96:99], v9 offset:4096
    s_waitcnt lgkmcnt(2)
    v_mfma_f32_32x32x16_bf16 v[64:79], v[104:107], v[4:7], 0
    s_cmp_eq_u32 s58, 8
    s_nop 5
    v_max3_f32 v11, v32, v33, v11
    v_max3_f32 v12, v34, v35, v12
    v_max3_f32 v11, v36, v37, v11
    v_max3_f32 v12, v38, v39, v12
    v_max3_f32 v11, v40, v41, v11
    v_max3_f32 v12, v42, v43, v12
    v_max3_f32 v11, v44, v45, v11
    v_max3_f32 v12, v46, v47, v12
    s_cbranch_scc1 L_P1X
    ds_read_b128 v[108:111], v9 offset:3072
    s_waitcnt lgkmcnt(2)
    v_mfma_f32_32x32x16_bf16 v[32:47], v[100:103], v[4:7], 0
    s_cmp_eq_u32 s58, 7
    s_nop 0
    v_max3_f32 v11, v48, v49, v11
    v_max3_f32 v12, v50, v51, v12
    v_max3_f32 v11, v52, v53, v11
    v_max3_f32 v12, v54, v55, v12
    v_max3_f32 v11, v56, v57, v11
    v_max3_f32 v12, v58, v59, v12
    v_max3_f32 v11, v60, v61, v11
    v_max3_f32 v12, v62, v63, v12
    s_cbranch_scc1 L_P1X
    ds_read_b128 v[104:107], v9 offset:2048
    s_waitcnt lgkmcnt(2)
    v_mfma_f32_32x32x16_bf16 v[48:63], v[96:99], v[4:7], 0
    s_cmp_eq_u32 s58, 6
    s_nop 0
    v_max3_f32 v11, v64, v65, v11
    v_max3_f32 v12, v66, v67, v12
    v_max3_f32 v11, v68, v69, v11
    v_max3_f32 v12, v70, v71, v12
    v_max3_f32 v11, v72, v73, v11
    v_max3_f32 v12, v74, v75, v12
    v_max3_f32 v11, v76, v77, v11
    v_max3_f32 v12, v78, v79, v12
    s_cbranch_scc1 L_P1X
    ds_read_b128 v[100:103], v9 offset:1024
    s_waitcnt lgkmcnt(2)
    v_mfma_f32_32x32x16_bf16 v[64:79], v[108:111], v[4:7], 0
    s_cmp_eq_u32 s58, 5
    s_nop 0
    v_max3_f32 v11, v32, v33, v11
    v_max3_f32 v12, v34, v35, v12
    v_max3_f32 v11, v36, v37, v11
    v_max3_f32 v12, v38, v39, v12
    v_max3_f32 v11, v40, v41, v11
    v_max3_f32 v12, v42, v43, v12
    v_max3_f32 v11, v44, v45, v11
    v_max3_f32 v12, v46, v47, v12
    s_cbranch_scc1 L_P1X
    ds_read_b128 v[96:99], v9 offset:0
    s_waitcnt lgkmcnt(2)
    v_mfma_f32_32x32x16_bf16 v[32:47], v[104:107], v[4:7], 0
    s_cmp_eq_u32 s58, 4
    s_nop 0
    v_max3_f32 v11, v48, v49, v11
    v_max3_f32 v12, v50, v51, v12
    v_max3_f32 v11, v52, v53, v11
    v_max3_f32 v12, v54, v55, v12
    v_max3_f32 v11, v56, v57, v11
    v_max3_f32 v12, v58, v59, v12
    v_max3_f32 v11, v60, v61, v11
    v_max3_f32 v12, v62, v63, v12
    s_cbranch_scc1 L_P1X
    s_waitcnt lgkmcnt(1)
    v_mfma_f32_32x32x16_bf16 v[48:63], v[100:103], v[4:7], 0
    s_cmp_eq_u32 s58, 3
    s_nop 0
    v_max3_f32 v11, v64, v65, v11
    v_max3_f32 v12, v66, v67, v12
    v_max3_f32 v11, v68, v69, v11
    v_max3_f32 v12, v70, v71, v12
    v_max3_f32 v11, v72, v73, v11
    v_max3_f32 v12, v74, v75, v12
    v_max3_f32 v11, v76, v77, v11
    v_max3_f32 v12, v78, v79, v12
    s_cbranch_scc1 L_P1X
    s_waitcnt lgkmcnt(0)
    v_mfma_f32_32x32x16_bf16 v[64:79], v[96:99], v[4:7], v[80:95]
    s_cmp_eq_u32 s58, 2
    s_nop 0
    v_max3_f32 v11, v32, v33, v11
    v_max3_f32 v12, v34, v35, v12
    v_max3_f32 v11, v36, v37, v11
    v_max3_f32 v12, v38, v39, v12
    v_max3_f32 v11, v40, v41, v11
    v_max3_f32 v12, v42, v43, v12
    v_max3_f32 v11, v44, v45, v11
    v_max3_f32 v12, v46, v47, v12
    s_cbranch_scc1 L_P1X
    s_cmp_eq_u32 s58, 1
    v_max3_f32 v11, v48, v49, v11
    v_max3_f32 v12, v50, v51, v12
    v_max3_f32 v11, v52, v53, v11
    v_max3_f32 v12, v54, v55, v12
    v_max3_f32 v11, v56, v57, v11
    v_max3_f32 v12, v58, v59, v12
    v_max3_f32 v11, v60, v61, v11
    v_max3_f32 v12, v62, v63, v12
    s_cbranch_scc1 L_P1X
    s_nop 0
    v_max3_f32 v11, v64, v65, v11
    v_max3_f32 v12, v66, v67, v12
    v_max3_f32 v11, v68, v69, v11
    v_max3_f32 v12, v70, v71, v12
    v_max3_f32 v11, v72, v73, v11
    v_max3_f32 v12, v74, v75, v12
    v_max3_f32 v11, v76, v77, v11
    v_max3_f32 v12, v78, v79, v12
L_P1X:
    s_waitcnt vmcnt(1) lgkmcnt(0)
    s_barrier
    s_mov_b32 s90, 0xffff
    s_mov_b32 s91, 0xffff
    ds_read_b128 v[104:107], v9 offset:8192
    ds_read_b128 v[108:111], v9 offset:7168
    s_mov_b64 exec, s[90:91]
    ds_read_b128 v[112:115], v10 offset:8192
    ds_read_b128 v[116:119], v10 offset:8704
    s_mov_b64 exec, -1
    v_max_f32 v11, v11, v12
    v_mov_b32 v12, v11
    s_nop 1
    v_permlane32_swap_b32 v11, v12
    v_max_f32 v11, v11, v12
    v_sub_f32 v64, 0, v11
    v_sub_f32 v65, 0, v11
    v_mov_b64 v[66:67], v[64:65]
    v_mov_b64 v[68:69], v[64:65]
    v_mov_b64 v[70:71], v[64:65]
    v_mov_b64 v[72:73], v[64:65]
    v_mov_b64 v[74:75], v[64:65]
    v_mov_b64 v[76:77], v[64:65]
    v_mov_b64 v[78:79], v[64:65]
    s_waitcnt lgkmcnt(0)
    s_nop 0
    v_mfma_f32_32x32x16_bf16 v[32:47], v[104:107], v[4:7], v[64:79]
    s_mov_b32 s101, 0
    s_waitcnt vmcnt(0)
L_REGC:
    v_cmp_ne_u32 vcc, s50, v24
    s_nop 0
    s_cmp_lg_u32 vcc_lo, 0
    s_cbranch_scc1 L_REGRT
L_REGOK:
    v_cmp_eq_u32_e64 vcc, s3, v24
    s_nop 0
    s_cmp_eq_u32 vcc_hi, -1
    s_cselect_b32 s51, 1, 0
    s_cmp_eq_u32 s68, 2
    s_cbranch_scc0 L_NOPUB
    s_lshl_b32 s54, s41, 12
    s_lshl_b32 s59, s48, 8
    s_add_u32 s54, s54, s59
    s_lshl_b32 s59, s49, 5
    s_add_u32 s54, s54, s59
    s_add_u32 s54, s54, 459904
    s_mov_b64 exec, 1
    s_cmp_eq_u32 s51, 0
    s_cbranch_scc1 SLOW_6
    buffer_store_dwordx4 v[136:139], v2, s[12:15], s54 offen
    buffer_store_dwordx4 v[140:143], v2, s[12:15], s54 offen offset:16
JOIN_7:
    s_mov_b64 exec, -1
L_NOPUB:
    s_setprio 3
    v_exp_f32 v32, v32
    v_exp_f32 v33, v33
    v_exp_f32 v34, v34
    v_exp_f32 v35, v35
    s_mov_b64 exec, s[90:91]
    ds_read_b128 v[120:123], v10 offset:7168
    ds_read_b128 v[124:127], v10 offset:7680
    s_mov_b64 exec, -1
    v_exp_f32 v36, v36
    v_exp_f32 v37, v37
    v_exp_f32 v38, v38
    v_exp_f32 v39, v39
    v_exp_f32 v40, v40
    v_mfma_f32_32x32x16_bf16 v[48:63], v[108:111], v[4:7], v[64:79]
    ds_read_b128 v[104:107], v9 offset:6144
    v_cvt_pk_bf16_f32 v96, v32, v33
    v_cvt_pk_bf16_f32 v97, v34, v35
    v_cvt_pk_bf16_f32 v98, v36, v37
    v_cvt_pk_bf16_f32 v99, v38, v39
    v_bfi_b32 v96, v16, 0, v96
    v_bfi_b32 v97, v17, 0, v97
    v_bfi_b32 v98, v18, 0, v98
    v_bfi_b32 v99, v19, 0, v99
    buffer_load_dwordx4 v[128:131], v2, s[12:15], s70 offen offset:0 sc1
    buffer_load_dwordx4 v[132:135], v2, s[12:15], s70 offen offset:1024 sc1
    v_exp_f32 v41, v41
    v_exp_f32 v42, v42
    v_exp_f32_e64 v43, v43
    v_mfma_f32_32x32x16_bf16 v[80:95], v[112:115], v[96:99], 0
    buffer_load_dwordx4 v[136:139], v2, s[12:15], s70 offen offset:2048 sc1
    buffer_load_dwordx4 v[140:143], v2, s[12:15], s70 offen offset:3072 sc1
    v_exp_f32 v44, v44
    v_exp_f32 v45, v45
    v_exp_f32 v46, v46
    v_exp_f32_e64 v47, v47
    s_cmp_eq_u32 s58, 8
    v_cvt_pk_bf16_f32 v100, v40, v41
    v_cvt_pk_bf16_f32 v101, v42, v43
    v_cvt_pk_bf16_f32 v102, v44, v45
    v_cvt_pk_bf16_f32 v103, v46, v47
    v_bfi_b32 v100, v20, 0, v100
    v_bfi_b32 v101, v21, 0, v101
    v_bfi_b32 v102, v22, 0, v102
    v_bfi_b32 v103, v23, 0, v103
    s_cbranch_scc1 L_P2X8
    v_exp_f32 v48, v48
    v_exp_f32 v49, v49
    v_exp_f32 v50, v50
    v_exp_f32_e64 v51, v51
    v_mfma_f32_32x32x16_bf16 v[80:95], v[116:119], v[100:103], v[80:95]
    s_waitcnt lgkmcnt(0)
    s_mov_b64 exec, s[90:91]
    ds_read_b128 v[112:115], v10 offset:6144
    ds_read_b128 v[116:119], v10 offset:6656
    s_mov_b64 exec, -1
    v_exp_f32 v52, v52
    v_exp_f32 v53, v53
    v_exp_f32 v54, v54
    v_exp_f32 v55, v55
    v_exp_f32 v56, v56
    v_mfma_f32_32x32x16_bf16 v[32:47], v[104:107], v[4:7], v[64:79]
    ds_read_b128 v[108:111], v9 offset:5120
    v_cvt_pk_bf16_f32 v96, v48, v49
    v_cvt_pk_bf16_f32 v97, v50, v51
    v_cvt_pk_bf16_f32 v98, v52, v53
    v_cvt_pk_bf16_f32 v99, v54, v55
    buffer_load_dwordx4 v[144:147], v2, s[12:15], s71 offen offset:0 sc1
    buffer_load_dwordx4 v[148:151], v2, s[12:15], s71 offen offset:1024 sc1
    v_exp_f32 v57, v57
    v_exp_f32 v58, v58
    v_exp_f32_e64 v59, v59
    v_mfma_f32_32x32x16_bf16 v[80:95], v[120:123], v[96:99], v[80:95]
    buffer_load_dwordx4 v[152:155], v2, s[12:15], s71 offen offset:2048 sc1
    buffer_load_dwordx4 v[156:159], v2, s[12:15], s71 offen offset:3072 sc1
    v_exp_f32 v60, v60
    v_exp_f32 v61, v61
    v_exp_f32 v62, v62
    v_exp_f32_e64 v63, v63
    s_cmp_eq_u32 s58, 7
    v_cvt_pk_bf16_f32 v100, v56, v57
    v_cvt_pk_bf16_f32 v101, v58, v59
    v_cvt_pk_bf16_f32 v102, v60, v61
    v_cvt_pk_bf16_f32 v103, v62, v63
    s_cbranch_scc1 L_P2X7
    s_setprio 2
    v_exp_f32 v32, v32
    v_exp_f32 v33, v33
    v_exp_f32 v34, v34
    v_exp_f32 v35, v35
    v_mfma_f32_32x32x16_bf16 v[80:95], v[124:127], v[100:103], v[80:95]
    s_waitcnt lgkmcnt(0)
    s_mov_b64 exec, s[90:91]
    ds_read_b128 v[120:123], v10 offset:5120
    ds_read_b128 v[124:127], v10 offset:5632
    s_mov_b64 exec, -1
    v_exp_f32 v36, v36
    v_exp_f32 v37, v37
    v_exp_f32 v38, v38
    v_exp_f32 v39, v39
    v_exp_f32 v40, v40
    v_mfma_f32_32x32x16_bf16 v[48:63], v[108:111], v[4:7], v[64:79]
    ds_read_b128 v[104:107], v9 offset:4096
    v_cvt_pk_bf16_f32 v96, v32, v33
    v_cvt_pk_bf16_f32 v97, v34, v35
    v_cvt_pk_bf16_f32 v98, v36, v37
    v_cvt_pk_bf16_f32 v99, v38, v39
    buffer_load_dwordx4 v[160:163], v2, s[12:15], s72 offen offset:0 sc1
    buffer_load_dwordx4 v[164:167], v2, s[12:15], s72 offen offset:1024 sc1
    v_exp_f32 v41, v41
    v_exp_f32 v42, v42
    v_exp_f32_e64 v43, v43
    v_mfma_f32_32x32x16_bf16 v[80:95], v[112:115], v[96:99], v[80:95]
    buffer_load_dwordx4 v[168:171], v2, s[12:15], s72 offen offset:2048 sc1
    v_exp_f32 v44, v44
    v_exp_f32 v45, v45
    v_exp_f32 v46, v46
    v_exp_f32_e64 v47, v47
    s_cmp_eq_u32 s58, 6
    v_cvt_pk_bf16_f32 v100, v40, v41
    v_cvt_pk_bf16_f32 v101, v42, v43
    v_cvt_pk_bf16_f32 v102, v44, v45
    v_cvt_pk_bf16_f32 v103, v46, v47
    s_cbranch_scc1 L_P2X6
    v_exp_f32 v48, v48
    v_exp_f32 v49, v49
    v_exp_f32 v50, v50
    v_exp_f32_e64 v51, v51
    v_mfma_f32_32x32x16_bf16 v[80:95], v[116:119], v[100:103], v[80:95]
    s_waitcnt lgkmcnt(0)
    s_mov_b64 exec, s[90:91]
    ds_read_b128 v[112:115], v10 offset:4096
    ds_read_b128 v[116:119], v10 offset:4608
    s_mov_b64 exec, -1
    v_exp_f32 v52, v52
    v_exp_f32 v53, v53
    v_exp_f32 v54, v54
    v_exp_f32 v55, v55
    v_exp_f32 v56, v56
    v_mfma_f32_32x32x16_bf16 v[32:47], v[104:107], v[4:7], v[64:79]
    ds_read_b128 v[108:111], v9 offset:3072
    v_cvt_pk_bf16_f32 v96, v48, v49
    v_cvt_pk_bf16_f32 v97, v50, v51
    v_cvt_pk_bf16_f32 v98, v52, v53
    v_cvt_pk_bf16_f32 v99, v54, v55
    buffer_load_dwordx4 v[172:175], v2, s[12:15], s72 offen offset:3072 sc1
    buffer_load_dwordx4 v[176:179], v2, s[12:15], s73 offen offset:0 sc1
    v_exp_f32 v57, v57
    v_exp_f32 v58, v58
    v_exp_f32_e64 v59, v59
    v_mfma_f32_32x32x16_bf16 v[80:95], v[120:123], v[96:99], v[80:95]
    buffer_load_dwordx4 v[180:183], v2, s[12:15], s73 offen offset:1024 sc1
    v_exp_f32 v60, v60
    v_exp_f32 v61, v61
    v_exp_f32 v62, v62
    v_exp_f32_e64 v63, v63
    s_cmp_eq_u32 s58, 5
    v_cvt_pk_bf16_f32 v100, v56, v57
    v_cvt_pk_bf16_f32 v101, v58, v59
    v_cvt_pk_bf16_f32 v102, v60, v61
    v_cvt_pk_bf16_f32 v103, v62, v63
    s_cbranch_scc1 L_P2X5
    s_setprio 1
    v_exp_f32 v32, v32
    v_exp_f32 v33, v33
    v_exp_f32 v34, v34
    v_exp_f32 v35, v35
    v_mfma_f32_32x32x16_bf16 v[80:95], v[124:127], v[100:103], v[80:95]
    s_waitcnt lgkmcnt(0)
    s_mov_b64 exec, s[90:91]
    ds_read_b128 v[120:123], v10 offset:3072
    ds_read_b128 v[124:127], v10 offset:3584
    s_mov_b64 exec, -1
    v_exp_f32 v36, v36
    v_exp_f32 v37, v37
    v_exp_f32 v38, v38
    v_exp_f32 v39, v39
    v_exp_f32 v40, v40
    v_mfma_f32_32x32x16_bf16 v[48:63], v[108:111], v[4:7], v[64:79]
    ds_read_b128 v[104:107], v9 offset:2048
    v_cvt_pk_bf16_f32 v96, v32, v33
    v_cvt_pk_bf16_f32 v97, v34, v35
    v_cvt_pk_bf16_f32 v98, v36, v37
    v_cvt_pk_bf16_f32 v99, v38, v39
    buffer_load_dwordx4 v[184:187], v2, s[12:15], s73 offen offset:2048 sc1
    buffer_load_dwordx4 v[188:191], v2, s[12:15], s73 offen offset:3072 sc1
    v_exp_f32 v41, v41
    v_exp_f32 v42, v42
    v_exp_f32_e64 v43, v43
    v_mfma_f32_32x32x16_bf16 v[80:95], v[112:115], v[96:99], v[80:95]
    buffer_load_dwordx4 v[192:195], v2, s[12:15], s74 offen offset:0 sc1
    v_exp_f32 v44, v44
    v_exp_f32 v45, v45
    v_exp_f32 v46, v46
    v_exp_f32_e64 v47, v47
    s_cmp_eq_u32 s58, 4
    v_cvt_pk_bf16_f32 v100, v40, v41
    v_cvt_pk_bf16_f32 v101, v42, v43
    v_cvt_pk_bf16_f32 v102, v44, v45
    v_cvt_pk_bf16_f32 v103, v46, v47
    s_cbranch_scc1 L_P2X4
    v_exp_f32 v48, v48
    v_exp_f32 v49, v49
    v_exp_f32 v50, v50
    v_exp_f32_e64 v51, v51
    v_mfma_f32_32x32x16_bf16 v[80:95], v[116:119], v[100:103], v[80:95]
    s_waitcnt lgkmcnt(0)
    s_mov_b64 exec, s[90:91]
    ds_read_b128 v[112:115], v10 offset:2048
    ds_read_b128 v[116:119], v10 offset:2560
    s_mov_b64 exec, -1
    v_exp_f32 v52, v52
    v_exp_f32 v53, v53
    v_exp_f32 v54, v54
    v_exp_f32 v55, v55
    v_exp_f32 v56, v56
    v_mfma_f32_32x32x16_bf16 v[32:47], v[104:107], v[4:7], v[64:79]
    ds_read_b128 v[108:111], v9 offset:1024
    v_cvt_pk_bf16_f32 v96, v48, v49
    v_cvt_pk_bf16_f32 v97, v50, v51
    v_cvt_pk_bf16_f32 v98, v52, v53
    v_cvt_pk_bf16_f32 v99, v54, v55
    buffer_load_dwordx4 v[196:199], v2, s[12:15], s74 offen offset:1024 sc1
    buffer_load_dwordx4 v[200:203], v2, s[12:15], s74 offen offset:2048 sc1
    v_exp_f32 v57, v57
    v_exp_f32 v58, v58
    v_exp_f32_e64 v59, v59
    v_mfma_f32_32x32x16_bf16 v[80:95], v[120:123], v[96:99], v[80:95]
    buffer_load_dwordx4 v[204:207], v2, s[12:15], s74 offen offset:3072 sc1
    v_exp_f32 v60, v60
    v_exp_f32 v61, v61
    v_exp_f32 v62, v62
    v_exp_f32_e64 v63, v63
    s_cmp_eq_u32 s58, 3
    v_cvt_pk_bf16_f32 v100, v56, v57
    v_cvt_pk_bf16_f32 v101, v58, v59
    v_cvt_pk_bf16_f32 v102, v60, v61
    v_cvt_pk_bf16_f32 v103, v62, v63
    s_cbranch_scc1 L_P2X3
    s_setprio 0
    v_exp_f32 v32, v32
    v_exp_f32 v33, v33
    v_exp_f32 v34, v34
    v_exp_f32 v35, v35
    v_mfma_f32_32x32x16_bf16 v[80:95], v[124:127], v[100:103], v[80:95]
    s_waitcnt lgkmcnt(0)
    s_mov_b64 exec, s[90:91]
    ds_read_b128 v[120:123], v10 offset:1024
    ds_read_b128 v[124:127], v10 offset:1536
    s_mov_b64 exec, -1
    v_exp_f32 v36, v36
    v_exp_f32 v37, v37
    v_exp_f32 v38, v38
    v_exp_f32 v39, v39
    v_exp_f32 v40, v40
    v_mfma_f32_32x32x16_bf16 v[48:63], v[108:111], v[4:7], v[64:79]
    ds_read_b128 v[104:107], v9 offset:0
    v_cvt_pk_bf16_f32 v96, v32, v33
    v_cvt_pk_bf16_f32 v97, v34, v35
    v_cvt_pk_bf16_f32 v98, v36, v37
    v_cvt_pk_bf16_f32 v99, v38, v39
    v_exp_f32 v41, v41
    v_exp_f32 v42, v42
    v_exp_f32_e64 v43, v43
    v_mfma_f32_32x32x16_bf16 v[80:95], v[112:115], v[96:99], v[80:95]
    v_exp_f32 v44, v44
    v_exp_f32 v45, v45
    v_exp_f32 v46, v46
    v_exp_f32_e64 v47, v47
    s_cmp_eq_u32 s58, 2
    v_cvt_pk_bf16_f32 v100, v40, v41
    v_cvt_pk_bf16_f32 v101, v42, v43
    v_cvt_pk_bf16_f32 v102, v44, v45
    v_cvt_pk_bf16_f32 v103, v46, v47
    s_cbranch_scc1 L_P2X2
    v_exp_f32 v48, v48
    v_exp_f32 v49, v49
    v_exp_f32 v50, v50
    v_exp_f32_e64 v51, v51
    v_mfma_f32_32x32x16_bf16 v[80:95], v[116:119], v[100:103], v[80:95]
    s_waitcnt lgkmcnt(0)
    s_mov_b64 exec, s[90:91]
    ds_read_b128 v[112:115], v10 offset:0
    ds_read_b128 v[116:119], v10 offset:512
    s_mov_b64 exec, -1
    v_exp_f32 v52, v52
    v_exp_f32 v53, v53
    v_exp_f32 v54, v54
    v_exp_f32 v55, v55
    v_exp_f32 v56, v56
    v_mfma_f32_32x32x16_bf16 v[32:47], v[104:107], v[4:7], v[64:79]
    v_cvt_pk_bf16_f32 v96, v48, v49
    v_cvt_pk_bf16_f32 v97, v50, v51
    v_cvt_pk_bf16_f32 v98, v52, v53
    v_cvt_pk_bf16_f32 v99, v54, v55
    v_exp_f32 v57, v57
    v_exp_f32 v58, v58
    v_exp_f32_e64 v59, v59
    v_mfma_f32_32x32x16_bf16 v[80:95], v[120:123], v[96:99], v[80:95]
    v_exp_f32 v60, v60
    v_exp_f32 v61, v61
    v_exp_f32 v62, v62
    v_exp_f32_e64 v63, v63
    s_cmp_eq_u32 s58, 1
    v_cvt_pk_bf16_f32 v100, v56, v57
    v_cvt_pk_bf16_f32 v101, v58, v59
    v_cvt_pk_bf16_f32 v102, v60, v61
    v_cvt_pk_bf16_f32 v103, v62, v63
    s_cbranch_scc1 L_P2X1
    v_exp_f32 v32, v32
    v_exp_f32 v33, v33
    v_exp_f32 v34, v34
    v_exp_f32_e64 v35, v35
    v_mfma_f32_32x32x16_bf16 v[80:95], v[124:127], v[100:103], v[80:95]
    s_waitcnt lgkmcnt(0)
    v_exp_f32 v36, v36
    v_exp_f32 v37, v37
    v_exp_f32 v38, v38
    v_exp_f32 v39, v39
    v_exp_f32 v40, v40
    v_cvt_pk_bf16_f32 v96, v32, v33
    v_cvt_pk_bf16_f32 v97, v34, v35
    v_cvt_pk_bf16_f32 v98, v36, v37
    v_cvt_pk_bf16_f32 v99, v38, v39
    v_and_b32 v96, v16, v96
    v_and_b32 v97, v17, v97
    v_and_b32 v98, v18, v98
    v_and_b32 v99, v19, v99
    v_exp_f32 v41, v41
    v_exp_f32 v42, v42
    v_exp_f32_e64 v43, v43
    v_mfma_f32_32x32x16_bf16 v[80:95], v[112:115], v[96:99], v[80:95]
    v_exp_f32 v44, v44
    v_exp_f32 v45, v45
    v_exp_f32 v46, v46
    v_exp_f32 v47, v47
    v_cvt_pk_bf16_f32 v100, v40, v41
    v_cvt_pk_bf16_f32 v101, v42, v43
    v_cvt_pk_bf16_f32 v102, v44, v45
    v_cvt_pk_bf16_f32 v103, v46, v47
    v_and_b32 v100, v20, v100
    v_and_b32 v101, v21, v101
    v_and_b32 v102, v22, v102
    v_and_b32_e64 v103, v23, v103
    s_nop 1
    v_mfma_f32_32x32x16_bf16 v[80:95], v[116:119], v[100:103], v[80:95]
L_P2E:
    s_setprio 0
    s_and_b32 s54, s43, 1
    s_lshl_b32 s52, s41, 12
    s_lshl_b32 s59, s54, 6
    s_add_u32 s52, s52, s59
    s_lshl_b32 s59, s44, 3
    s_add_u32 s52, s52, s59
    s_lshl_b32 s59, s45, 2
    s_add_u32 s52, s52, s59
    s_add_u32 s52, s52, 458752
    s_lshr_b32 s54, s48, 1
    s_lshl_b32 s53, s41, 12
    s_lshl_b32 s59, s54, 6
    s_add_u32 s53, s53, s59
    s_add_u32 s53, s53, 458752
    s_waitcnt lgkmcnt(0)
    v_rcp_f32 v12, v88
    s_nop 0
    v_pk_mul_f32 v[80:81], v[80:81], v[12:13] op_sel_hi:[1,0]
    v_pk_mul_f32 v[82:83], v[82:83], v[12:13] op_sel_hi:[1,0]
    v_pk_mul_f32 v[84:85], v[84:85], v[12:13] op_sel_hi:[1,0]
    v_pk_mul_f32 v[86:87], v[86:87], v[12:13] op_sel_hi:[1,0]
    v_cvt_pk_bf16_f32 v96, v80, v81
    v_cvt_pk_bf16_f32 v97, v82, v83
    v_cvt_pk_bf16_f32 v98, v84, v85
    v_cvt_pk_bf16_f32 v99, v86, v87
    buffer_store_dwordx4 v[96:99], v2, s[12:15], s98 offen sc1
    s_bitcmp1_b32 s68, 0
    s_cbranch_scc1 L_PREPLATE
L_PREPLR:
    s_lshl_b32 s57, s41, 18
    s_lshl_b32 s59, s48, 16
    s_add_u32 s57, s57, s59
    s_lshl_b32 s59, s47, 15
    s_add_u32 s57, s57, s59
    s_lshl_b32 s59, s46, 13
    s_add_u32 s57, s57, s59
    s_add_u32 s57, s57, 10485760
    s_add_u32 s58, s57, 4096
    v_lshrrev_b32 v21, 3, v1
    v_and_b32 v22, 7, v1
    v_lshlrev_b32 v25, 10, v21
    v_lshl_add_u32 v25, v22, 4, v25
    s_lshl_b32 s98, s41, 18
    s_lshl_b32 s59, s48, 16
    s_add_u32 s98, s98, s59
    s_lshl_b32 s59, s40, 13
    s_add_u32 s98, s98, s59
    s_lshl_b32 s59, s49, 7
    s_add_u32 s98, s98, s59
    v_bfe_u32 v21, v1, 2, 2
    v_lshrrev_b32 v22, 5, v1
    v_lshl_add_u32 v22, v22, 2, v21
    v_lshlrev_b32 v24, 7, v22
    v_lshrrev_b32 v21, 1, v21
    v_lshl_add_u32 v24, v21, 6, v24
    v_bfe_u32 v21, v1, 4, 1
    v_lshl_add_u32 v24, v21, 5, v24
    v_and_b32_e64 v21, 3, v1
    v_lshl_add_u32 v24, v21, 3, v24
    s_lshl_b32 s54, s46, 14
    s_add_u32 s54, s54, 65536
    v_add_u32 v24, s54, v24
    v_xor_b32 v17, 64, v24
    s_lshl_b32 s54, s46, 14
    s_lshl_b32 s59, s47, 13
    s_add_u32 s54, s54, s59
    v_and_b32 v21, 31, v1
    v_and_b32 v22, 7, v1
    v_bfe_u32 v23, v1, 1, 1
    v_lshl_add_u32 v22, v23, 3, v22
    v_lshrrev_b32 v23, 5, v1
    v_lshlrev_b32 v23, 3, v23
    v_xor_b32 v22, v22, v23
    v_lshlrev_b32 v22, 4, v22
    v_lshl_add_u32 v16, v21, 8, v22
    v_add_u32 v16, s54, v16
    v_lshrrev_b32 v21, 3, v1
    v_and_b32_e64 v22, 7, v1
    v_bfe_u32 v23, v21, 1, 1
    v_lshl_add_u32 v23, v23, 3, v21
    v_xor_b32 v23, v23, v22
    v_lshlrev_b32 v23, 4, v23
    v_lshl_add_u32 v26, v21, 8, v23
    s_lshl_b32 s54, s40, 11
    v_add_u32 v26, s54, v26
    v_xor_b32 v27, 128, v26
    s_mov_b32 s53, s53
    s_lshl_b32 s59, s46, 4
    s_add_u32 s53, s53, s59
    v_mov_b32 v28, s50
    v_lshlrev_b32_e64 v29, 2, v1
    s_mov_b32 s101, 0
    s_waitcnt vmcnt(0)
    s_barrier
    s_mov_b64 exec, 1
    s_cmp_lg_u32 s40, 0
    s_cbranch_scc1 L_OH_Q
    s_cmp_eq_u32 s51, 0
    s_cbranch_scc1 SLOW_10
    buffer_store_dword v28, v29, s[12:15], s52 offen
JOIN_11:
L_OH_Q:
    s_mov_b32 exec_lo, 15
L_OH_P:
    buffer_load_dword v30, v29, s[12:15], s53 offen sc1
    s_add_u32 s101, s101, 1
    s_cmp_gt_u32 s101, 131072
    s_cbranch_scc1 L_OH_X
    s_waitcnt vmcnt(0)
    v_cmp_ne_u32 vcc, s50, v30
    s_nop 0
    s_cbranch_vccnz L_OH_P
L_OH_X:
    s_mov_b64 exec, -1
    buffer_load_dwordx4 v[32:35], v2, s[12:15], s57 offen offset:0 sc1
    buffer_load_dwordx4 v[36:39], v2, s[12:15], s57 offen offset:1024 sc1
    buffer_load_dwordx4 v[40:43], v2, s[12:15], s57 offen offset:2048 sc1
    buffer_load_dwordx4 v[44:47], v2, s[12:15], s57 offen offset:3072 sc1
    buffer_load_dwordx4 v[48:51], v2, s[12:15], s58 offen offset:0 sc1
    buffer_load_dwordx4 v[52:55], v2, s[12:15], s58 offen offset:1024 sc1
    buffer_load_dwordx4 v[56:59], v2, s[12:15], s58 offen offset:2048 sc1
    buffer_load_dwordx4 v[60:63], v2, s[12:15], s58 offen offset:3072 sc1
    buffer_load_dwordx4 v[12:15], v25, s[4:7], s98 offen
    ds_read_b64_tr_b16 v[96:97], v24 offset:0
    ds_read_b64_tr_b16 v[98:99], v24 offset:1024
    ds_read_b64_tr_b16 v[100:101], v17 offset:0
    ds_read_b64_tr_b16 v[102:103], v17 offset:1024
    ds_read_b64_tr_b16 v[104:105], v24 offset:2048
    ds_read_b64_tr_b16 v[106:107], v24 offset:3072
    ds_read_b64_tr_b16 v[108:109], v17 offset:2048
    ds_read_b64_tr_b16 v[110:111], v17 offset:3072
    ds_read_b64_tr_b16 v[112:113], v24 offset:4096
    ds_read_b64_tr_b16 v[114:115], v24 offset:5120
    ds_read_b64_tr_b16 v[116:117], v17 offset:4096
    ds_read_b64_tr_b16 v[118:119], v17 offset:5120
    s_waitcnt vmcnt(8) lgkmcnt(8)
    s_nop 0
    v_mfma_f32_32x32x16_bf16 v[64:79], v[96:99], v[32:35], 0
    v_mfma_f32_32x32x16_bf16 v[80:95], v[100:103], v[32:35], 0
    ds_read_b64_tr_b16 v[96:97], v24 offset:6144
    ds_read_b64_tr_b16 v[98:99], v24 offset:7168
    ds_read_b64_tr_b16 v[100:101], v17 offset:6144
    ds_read_b64_tr_b16 v[102:103], v17 offset:7168
    s_waitcnt vmcnt(7) lgkmcnt(8)
    s_nop 0
    v_mfma_f32_32x32x16_bf16 v[64:79], v[104:107], v[36:39], v[64:79]
    v_mfma_f32_32x32x16_bf16 v[80:95], v[108:111], v[36:39], v[80:95]
    ds_read_b64_tr_b16 v[104:105], v24 offset:8192
    ds_read_b64_tr_b16 v[106:107], v24 offset:9216
    ds_read_b64_tr_b16 v[108:109], v17 offset:8192
    ds_read_b64_tr_b16 v[110:111], v17 offset:9216
    s_waitcnt vmcnt(6) lgkmcnt(8)
    s_nop 0
    v_mfma_f32_32x32x16_bf16 v[64:79], v[112:115], v[40:43], v[64:79]
    v_mfma_f32_32x32x16_bf16 v[80:95], v[116:119], v[40:43], v[80:95]
    ds_read_b64_tr_b16 v[112:113], v24 offset:10240
    ds_read_b64_tr_b16 v[114:115], v24 offset:11264
    ds_read_b64_tr_b16 v[116:117], v17 offset:10240
    ds_read_b64_tr_b16 v[118:119], v17 offset:11264
    s_waitcnt vmcnt(5) lgkmcnt(8)
    s_nop 0
    v_mfma_f32_32x32x16_bf16 v[64:79], v[96:99], v[44:47], v[64:79]
    v_mfma_f32_32x32x16_bf16 v[80:95], v[100:103], v[44:47], v[80:95]
    ds_read_b64_tr_b16 v[96:97], v24 offset:12288
    ds_read_b64_tr_b16 v[98:99], v24 offset:13312
    ds_read_b64_tr_b16 v[100:101], v17 offset:12288
    ds_read_b64_tr_b16 v[102:103], v17 offset:13312
    s_waitcnt vmcnt(4) lgkmcnt(8)
    s_nop 0
    v_mfma_f32_32x32x16_bf16 v[64:79], v[104:107], v[48:51], v[64:79]
    v_mfma_f32_32x32x16_bf16 v[80:95], v[108:111], v[48:51], v[80:95]
    ds_read_b64_tr_b16 v[104:105], v24 offset:14336
    ds_read_b64_tr_b16 v[106:107], v24 offset:15360
    ds_read_b64_tr_b16 v[108:109], v17 offset:14336
    ds_read_b64_tr_b16 v[110:111], v17 offset:15360
    s_waitcnt vmcnt(3) lgkmcnt(8)
    v_mfma_f32_32x32x16_bf16 v[64:79], v[112:115], v[52:55], v[64:79]
    v_mfma_f32_32x32x16_bf16 v[80:95], v[116:119], v[52:55], v[80:95]
    s_waitcnt vmcnt(2) lgkmcnt(4)
    v_mfma_f32_32x32x16_bf16 v[64:79], v[96:99], v[56:59], v[64:79]
    v_mfma_f32_32x32x16_bf16 v[80:95], v[100:103], v[56:59], v[80:95]
    s_waitcnt vmcnt(1) lgkmcnt(0)
    v_mfma_f32_32x32x16_bf16 v[64:79], v[104:107], v[60:63], v[64:79]
    v_mfma_f32_32x32x16_bf16 v[80:95], v[108:111], v[60:63], v[80:95]
    v_and_b32 v22, 7, v1
    v_lshlrev_b32_e64 v24, 5, v22
    v_add_u32 v24, 159744, v24
    v_xor_b32 v33, 16, v16
    v_xor_b32 v34, 32, v16
    v_xor_b32 v35, 48, v16
    v_xor_b32 v36, 64, v16
    v_xor_b32 v37, 80, v16
    v_xor_b32 v38, 96, v16
    v_xor_b32 v39, 112, v16
    s_nop 0
    s_nop 0
    ds_write_b128 v16, v[64:67]
    ds_write_b128 v33, v[68:71]
    ds_write_b128 v34, v[72:75]
    ds_write_b128 v35, v[76:79]
    ds_write_b128 v36, v[80:83]
    ds_write_b128 v37, v[84:87]
    ds_write_b128 v38, v[88:91]
    ds_write_b128 v39, v[92:95]
    buffer_load_dwordx4 v[208:211], v2, s[12:15], s75 offen offset:0 sc1
    buffer_load_dwordx4 v[212:215], v2, s[12:15], s75 offen offset:1024 sc1
    buffer_load_dwordx4 v[216:219], v2, s[12:15], s75 offen offset:2048 sc1
    buffer_load_dwordx4 v[220:223], v2, s[12:15], s75 offen offset:3072 sc1
    buffer_load_dwordx4 v[224:227], v2, s[12:15], s76 offen offset:0 sc1
    buffer_load_dwordx4 v[228:231], v2, s[12:15], s76 offen offset:1024 sc1
    buffer_load_dwordx4 v[232:235], v2, s[12:15], s76 offen offset:2048 sc1
    buffer_load_dwordx4 v[236:239], v2, s[12:15], s76 offen offset:3072 sc1
    buffer_load_dwordx4 v[240:243], v2, s[12:15], s77 offen offset:0 sc1
    buffer_load_dwordx4 v[244:247], v2, s[12:15], s77 offen offset:1024 sc1
    buffer_load_dwordx4 v[248:251], v2, s[12:15], s77 offen offset:2048 sc1
    buffer_load_dwordx4 v[252:255], v2, s[12:15], s77 offen offset:3072 sc1
    ds_read_b128 v[96:99], v24 offset:0
    ds_read_b128 v[100:103], v24 offset:16
    ds_read_b128 v[104:107], v24 offset:512
    ds_read_b128 v[108:111], v24 offset:528
    ds_read_b128 v[112:115], v24 offset:256
    ds_read_b128 v[116:119], v24 offset:272
    s_waitcnt vmcnt(12)
    v_lshlrev_b32 v4, 16, v12
    v_and_b32 v5, 0xffff0000, v12
    v_lshlrev_b32_e64 v6, 16, v13
    v_and_b32 v7, 0xffff0000, v13
    v_lshlrev_b32_e64 v8, 16, v14
    v_and_b32 v9, 0xffff0000, v14
    v_lshlrev_b32_e64 v10, 16, v15
    v_and_b32 v11, 0xffff0000, v15
    v_lshrrev_b32 v23, 3, v1
    v_lshlrev_b32_e64 v21, 4, v23
    s_lshl_b32 s53, s41, 16
    s_lshl_b32 s59, s48, 14
    s_add_u32 s53, s53, s59
    s_lshl_b32 s59, s49, 11
    s_add_u32 s53, s53, s59
    s_lshl_b32 s59, s40, 7
    s_add_u32 s53, s53, s59
    s_add_u32 s53, s53, 524288
    v_bfe_u32 v20, v1, 1, 2
    v_lshlrev_b32 v20, 10, v20
    v_and_b32 v22, 1, v1
    v_lshl_add_u32 v20, v22, 9, v20
    v_add_u32 v20, v20, v21
    s_lshr_b32 s54, s40, 2
    s_and_b32 s55, s40, 3
    s_lshl_b32 s57, s41, 18
    s_lshl_b32 s59, s48, 16
    s_add_u32 s57, s57, s59
    s_lshl_b32 s59, s54, 15
    s_add_u32 s57, s57, s59
    s_lshl_b32 s59, s49, 12
    s_add_u32 s57, s57, s59
    s_lshl_b32 s59, s55, 7
    s_add_u32 s57, s57, s59
    s_add_u32 s57, s57, 12582912
    s_waitcnt lgkmcnt(0)
    s_barrier
    ds_read_b128 v[32:35], v26 offset:0
    ds_read_b128 v[36:39], v27 offset:0
    ds_read_b128 v[40:43], v26 offset:16384
    ds_read_b128 v[44:47], v27 offset:16384
    ds_read_b128 v[48:51], v26 offset:32768
    ds_read_b128 v[52:55], v27 offset:32768
    ds_read_b128 v[56:59], v26 offset:49152
    ds_read_b128 v[60:63], v27 offset:49152
    s_waitcnt lgkmcnt(4)
    v_pk_add_f32 v[32:33], v[32:33], v[40:41]
    v_pk_add_f32 v[34:35], v[34:35], v[42:43]
    v_pk_add_f32 v[36:37], v[36:37], v[44:45]
    v_pk_add_f32 v[38:39], v[38:39], v[46:47]
    s_waitcnt lgkmcnt(0)
    v_pk_add_f32 v[48:49], v[48:49], v[56:57]
    v_pk_add_f32 v[50:51], v[50:51], v[58:59]
    v_pk_add_f32 v[52:53], v[52:53], v[60:61]
    v_pk_add_f32 v[54:55], v[54:55], v[62:63]
    v_pk_add_f32 v[32:33], v[32:33], v[48:49]
    v_pk_add_f32 v[34:35], v[34:35], v[50:51]
    v_pk_add_f32 v[36:37], v[36:37], v[52:53]
    v_pk_add_f32 v[38:39], v[38:39], v[54:55]
    v_pk_fma_f32 v[4:5], v[96:97], v[32:33], v[4:5]
    v_pk_fma_f32 v[6:7], v[98:99], v[34:35], v[6:7]
    v_pk_fma_f32 v[8:9], v[100:101], v[36:37], v[8:9]
    v_pk_fma_f32 v[10:11], v[102:103], v[38:39], v[10:11]
    v_pk_mul_f32 v[64:65], v[4:5], v[104:105]
    v_pk_mul_f32 v[66:67], v[6:7], v[106:107]
    v_pk_mul_f32 v[68:69], v[8:9], v[108:109]
    v_pk_mul_f32 v[70:71], v[10:11], v[110:111]
    v_cvt_pk_bf16_f32 v32, v64, v65
    v_cvt_pk_bf16_f32 v33, v66, v67
    v_cvt_pk_bf16_f32 v34, v68, v69
    v_cvt_pk_bf16_f32 v35, v70, v71
    buffer_store_dwordx4 v[32:35], v20, s[12:15], s57 offen sc1
    ds_read_b128 v[40:43], v24 offset:768
    ds_read_b128 v[44:47], v24 offset:784
    ds_read_b128 v[48:51], v24 offset:1024
    ds_read_b128 v[52:55], v24 offset:1040
    v_pk_add_f32 v[72:73], v[4:5], v[6:7]
    v_pk_mul_f32 v[74:75], v[4:5], v[4:5]
    v_pk_add_f32 v[76:77], v[64:65], v[66:67]
    v_pk_mul_f32 v[78:79], v[64:65], v[64:65]
    v_pk_mul_f32 v[80:81], v[64:65], v[104:105]
    v_pk_mul_f32 v[82:83], v[64:65], v[112:113]
    v_pk_fma_f32 v[74:75], v[6:7], v[6:7], v[74:75]
    v_pk_fma_f32 v[78:79], v[66:67], v[66:67], v[78:79]
    v_pk_fma_f32 v[80:81], v[66:67], v[106:107], v[80:81]
    v_pk_fma_f32 v[82:83], v[66:67], v[114:115], v[82:83]
    v_pk_add_f32 v[72:73], v[72:73], v[8:9]
    v_pk_add_f32 v[76:77], v[76:77], v[68:69]
    v_pk_fma_f32 v[74:75], v[8:9], v[8:9], v[74:75]
    v_pk_fma_f32 v[78:79], v[68:69], v[68:69], v[78:79]
    v_pk_fma_f32 v[80:81], v[68:69], v[108:109], v[80:81]
    v_pk_fma_f32 v[82:83], v[68:69], v[116:117], v[82:83]
    v_pk_add_f32 v[72:73], v[72:73], v[10:11]
    v_pk_add_f32 v[76:77], v[76:77], v[70:71]
    v_pk_fma_f32 v[74:75], v[10:11], v[10:11], v[74:75]
    v_pk_fma_f32 v[78:79], v[70:71], v[70:71], v[78:79]
    v_pk_fma_f32 v[80:81], v[70:71], v[110:111], v[80:81]
    v_pk_fma_f32 v[82:83], v[70:71], v[118:119], v[82:83]
    v_add_f32 v84, v72, v73
    v_add_f32 v85, v74, v75
    v_add_f32 v86, v76, v77
    v_add_f32 v88, v78, v79
    v_add_f32 v89, v80, v81
    v_add_f32 v90, v82, v83
    v_add_f32_dpp v84, v84, v84 quad_perm:[1,0,3,2] row_mask:0xf bank_mask:0xf
    v_add_f32_dpp v85, v85, v85 quad_perm:[1,0,3,2] row_mask:0xf bank_mask:0xf
    v_add_f32_dpp v86, v86, v86 quad_perm:[1,0,3,2] row_mask:0xf bank_mask:0xf
    v_add_f32_dpp v88, v88, v88 quad_perm:[1,0,3,2] row_mask:0xf bank_mask:0xf
    v_add_f32_dpp v89, v89, v89 quad_perm:[1,0,3,2] row_mask:0xf bank_mask:0xf
    v_add_f32_dpp v90, v90, v90 quad_perm:[1,0,3,2] row_mask:0xf bank_mask:0xf
    v_add_f32_dpp v84, v84, v84 quad_perm:[2,3,0,1] row_mask:0xf bank_mask:0xf
    v_add_f32_dpp v85, v85, v85 quad_perm:[2,3,0,1] row_mask:0xf bank_mask:0xf
    v_add_f32_dpp v86, v86, v86 quad_perm:[2,3,0,1] row_mask:0xf bank_mask:0xf
    v_add_f32_dpp v88, v88, v88 quad_perm:[2,3,0,1] row_mask:0xf bank_mask:0xf
    v_add_f32_dpp v89, v89, v89 quad_perm:[2,3,0,1] row_mask:0xf bank_mask:0xf
    v_add_f32_dpp v90, v90, v90 quad_perm:[2,3,0,1] row_mask:0xf bank_mask:0xf
    v_add_f32_dpp v84, v84, v84 row_half_mirror row_mask:0xf bank_mask:0xf
    v_add_f32_dpp v85, v85, v85 row_half_mirror row_mask:0xf bank_mask:0xf
    v_add_f32_dpp v86, v86, v86 row_half_mirror row_mask:0xf bank_mask:0xf
    v_add_f32_dpp v88, v88, v88 row_half_mirror row_mask:0xf bank_mask:0xf
    v_add_f32_dpp v89, v89, v89 row_half_mirror row_mask:0xf bank_mask:0xf
    v_add_f32_dpp v90, v90, v90 row_half_mirror row_mask:0xf bank_mask:0xf
    s_mov_b32 exec_lo, 0x01010101
    s_mov_b32 exec_hi, 0x01010101
    buffer_store_dwordx4 v[84:87], v21, s[12:15], s53 offen sc1
    buffer_store_dwordx4 v[88:91], v21, s[12:15], s53 offen offset:1024 sc1
    s_mov_b64 exec, -1
    s_waitcnt lgkmcnt(0)
    v_pk_fma_f32 v[12:13], v[40:41], v[48:49], v[4:5]
    v_pk_fma_f32 v[14:15], v[42:43], v[50:51], v[6:7]
    v_pk_fma_f32 v[16:17], v[44:45], v[52:53], v[8:9]
    v_pk_fma_f32 v[18:19], v[46:47], v[54:55], v[10:11]
    s_lshl_b32 s58, s47, 15
    s_lshl_b32 s59, s46, 11
    s_add_u32 s58, s58, s59
    s_add_u32 s58, s58, 65536
    s_lshl_b32 s57, s41, 18
    s_lshl_b32 s59, s48, 16
    s_add_u32 s57, s57, s59
    s_add_u32 s57, s57, s58
    s_add_u32 s57, s57, 12517376
    v_add_u32 v24, 65536, v2
    v_mov_b32 v22, 0xbdd2d3e8
    v_mov_b32 v10, 0xc0135761
    s_lshl_b32 s55, s40, 11
    s_add_u32 s55, s55, 131072
    v_add_u32 v9, s55, v2
    v_and_b32 v21, 31, v1
    v_min_u32 v20, 2, v21
    v_lshlrev_b32 v20, 8, v20
    v_lshrrev_b32_e64 v23, 5, v1
    v_lshl_add_u32 v20, v23, 4, v20
    v_add_u32 v20, 162048, v20
    ds_read_b128 v[96:99], v20 offset:0
    ds_read_b128 v[100:103], v20 offset:32
    ds_read_b128 v[104:107], v20 offset:64
    ds_read_b128 v[108:111], v20 offset:96
    ds_read_b128 v[112:115], v20 offset:128
    ds_read_b128 v[116:119], v20 offset:160
    ds_read_b128 v[120:123], v20 offset:192
    ds_read_b128 v[124:127], v20 offset:224
    v_lshlrev_b32 v21, 4, v21
    v_lshrrev_b32 v20, 2, v21
    v_add_u32 v21, 162816, v21
    s_lshl_b32 s55, s40, 7
    s_add_u32 s55, s55, 161024
    v_add_u32 v20, s55, v20
    ds_read_b32 v11, v20
    s_lshl_b32 s56, s41, 17
    s_lshl_b32 s59, s49, 14
    s_add_u32 s56, s56, s59
    s_lshl_b32 s59, s40, 11
    s_add_u32 s56, s56, s59
    s_lshl_b32 s59, s48, 9
    s_add_u32 s56, s56, s59
    s_add_u32 s56, s56, 1048576
    s_lshl_b32 s53, s41, 12
    s_lshl_b32 s59, s48, 7
    s_add_u32 s53, s53, s59
    s_add_u32 s53, s53, 458880
    s_lshl_b32 s52, s49, 2
    s_add_u32 s52, s52, s53
    s_setprio 2
    v_mov_b32 v28, s50
    v_lshlrev_b32_e64 v29, 2, v1
    s_mov_b32 s101, 0
    s_waitcnt vmcnt(0)
    s_barrier
    s_cmp_lg_u32 s40, 7
    s_cbranch_scc1 L_YH_B
    s_mov_b64 exec, 1
    s_cmp_eq_u32 s51, 0
    s_cbranch_scc1 SLOW_12
    buffer_store_dword v28, v29, s[12:15], s52 offen
JOIN_13:
    s_mov_b32 exec_lo, 255
L_YH_P:
    buffer_load_dword v30, v29, s[12:15], s53 offen sc1
    s_add_u32 s101, s101, 1
    s_cmp_gt_u32 s101, 131072
    s_cbranch_scc1 L_YH_X
    s_waitcnt vmcnt(0)
    v_cmp_ne_u32_e64 vcc, s50, v30
    s_nop 0
    s_cbranch_vccnz L_YH_P
L_YH_X:
    s_mov_b64 exec, -1
    s_branch L_YH_W
L_YH_B:
    s_waitcnt lgkmcnt(0)
    s_cmp_lg_u32 s48, 0
    s_cbranch_scc1 AUG_14_1
    v_mfma_f32_32x32x16_bf16 v[64:79], v[96:99], v[128:131], 0
    v_mfma_f32_32x32x16_bf16 v[64:79], v[100:103], v[132:135], v[64:79]
    v_mfma_f32_32x32x16_bf16 v[64:79], v[104:107], v[136:139], v[64:79]
    v_mfma_f32_32x32x16_bf16 v[64:79], v[108:111], v[140:143], v[64:79]
    v_mfma_f32_32x32x16_bf16 v[64:79], v[112:115], v[144:147], v[64:79]
    v_mfma_f32_32x32x16_bf16 v[64:79], v[116:119], v[148:151], v[64:79]
    v_mfma_f32_32x32x16_bf16 v[64:79], v[120:123], v[152:155], v[64:79]
    v_mfma_f32_32x32x16_bf16 v[64:79], v[124:127], v[156:159], v[64:79]
    s_branch AUG_14_E
AUG_14_1:
    s_cmp_lg_u32 s48, 1
    s_cbranch_scc1 AUG_14_2
    s_nop 0
    v_mfma_f32_32x32x16_bf16 v[64:79], v[96:99], v[160:163], 0
    v_mfma_f32_32x32x16_bf16 v[64:79], v[100:103], v[164:167], v[64:79]
    v_mfma_f32_32x32x16_bf16 v[64:79], v[104:107], v[168:171], v[64:79]
    v_mfma_f32_32x32x16_bf16 v[64:79], v[108:111], v[172:175], v[64:79]
    v_mfma_f32_32x32x16_bf16 v[64:79], v[112:115], v[176:179], v[64:79]
    v_mfma_f32_32x32x16_bf16 v[64:79], v[116:119], v[180:183], v[64:79]
    v_mfma_f32_32x32x16_bf16 v[64:79], v[120:123], v[184:187], v[64:79]
    v_mfma_f32_32x32x16_bf16 v[64:79], v[124:127], v[188:191], v[64:79]
    s_branch AUG_14_E
AUG_14_2:
    s_cmp_lg_u32 s48, 2
    s_cbranch_scc1 AUG_14_3
    s_nop 0
    v_mfma_f32_32x32x16_bf16 v[64:79], v[96:99], v[192:195], 0
    v_mfma_f32_32x32x16_bf16 v[64:79], v[100:103], v[196:199], v[64:79]
    v_mfma_f32_32x32x16_bf16 v[64:79], v[104:107], v[200:203], v[64:79]
    v_mfma_f32_32x32x16_bf16 v[64:79], v[108:111], v[204:207], v[64:79]
    v_mfma_f32_32x32x16_bf16 v[64:79], v[112:115], v[208:211], v[64:79]
    v_mfma_f32_32x32x16_bf16 v[64:79], v[116:119], v[212:215], v[64:79]
    v_mfma_f32_32x32x16_bf16 v[64:79], v[120:123], v[216:219], v[64:79]
    v_mfma_f32_32x32x16_bf16 v[64:79], v[124:127], v[220:223], v[64:79]
    s_branch AUG_14_E
AUG_14_3:
    s_nop 0
    v_mfma_f32_32x32x16_bf16 v[64:79], v[96:99], v[224:227], 0
    v_mfma_f32_32x32x16_bf16 v[64:79], v[100:103], v[228:231], v[64:79]
    v_mfma_f32_32x32x16_bf16 v[64:79], v[104:107], v[232:235], v[64:79]
    v_mfma_f32_32x32x16_bf16 v[64:79], v[108:111], v[236:239], v[64:79]
    v_mfma_f32_32x32x16_bf16 v[64:79], v[112:115], v[240:243], v[64:79]
    v_mfma_f32_32x32x16_bf16 v[64:79], v[116:119], v[244:247], v[64:79]
    v_mfma_f32_32x32x16_bf16 v[64:79], v[120:123], v[248:251], v[64:79]
    v_mfma_f32_32x32x16_bf16 v[64:79], v[124:127], v[252:255], v[64:79]
AUG_14_E:
L_YH_W:
    s_barrier
    s_add_u32 m0, s58, 0
    s_nop 0
    buffer_load_dwordx4 v2, s[12:15], s57 offen offset:0 sc1 lds
    buffer_load_dwordx4 v2, s[12:15], s57 offen offset:1024 sc1 lds
    s_setprio 1
    s_add_u32 m0, s58, 8192
    s_add_u32 s57, s57, 8192
    buffer_load_dwordx4 v2, s[12:15], s57 offen offset:0 sc1 lds
    buffer_load_dwordx4 v2, s[12:15], s57 offen offset:1024 sc1 lds
    s_cmp_eq_u32 s40, 7
    s_cbranch_scc1 L_P5W7
    v_mov_b32 v67, s50
    s_mov_b32 exec_hi, 0
    buffer_store_dwordx4 v[64:67], v2, s[12:15], s56 offen sc1
    s_mov_b64 exec, -1
    s_mul_i32 s52, s41, 917504
    s_mul_i32 s59, s48, 229376
    s_add_u32 s52, s52, s59
    s_mul_i32 s59, s49, 14336
    s_add_u32 s52, s52, s59
    s_lshl_b32 s59, s40, 11
    s_add_u32 s52, s52, s59
    s_add_u32 s52, s52, 14680064
    s_add_u32 s53, s52, 114688
    s_lshl_b32 s54, s41, 17
    s_lshl_b32 s59, s49, 14
    s_add_u32 s54, s54, s59
    s_lshl_b32 s59, s40, 11
    s_add_u32 s54, s54, s59
    s_add_u32 s54, s54, 1048576
    s_waitcnt vmcnt(3)
    s_barrier
    ds_read_b128 v[96:99], v24 offset:0
    ds_read_b128 v[100:103], v24 offset:32768
    ds_read_b128 v[104:107], v24 offset:1024
    ds_read_b128 v[108:111], v24 offset:33792
    ds_read_b128 v[112:115], v24 offset:2048
    ds_read_b128 v[116:119], v24 offset:34816
    ds_read_b128 v[120:123], v24 offset:3072
    ds_read_b128 v[124:127], v24 offset:35840
    s_waitcnt lgkmcnt(6)
    s_nop 0
    v_mfma_f32_32x32x16_bf16 v[32:47], v[128:131], v[96:99], 0
    v_mfma_f32_32x32x16_bf16 v[48:63], v[128:131], v[100:103], 0
    s_add_u32 m0, s58, 16384
    s_add_u32 s57, s57, 8192
    buffer_load_dwordx4 v2, s[12:15], s57 offen offset:0 sc1 lds
    ds_read_b128 v[96:99], v24 offset:4096
    ds_read_b128 v[100:103], v24 offset:36864
    s_waitcnt lgkmcnt(6)
    v_mfma_f32_32x32x16_bf16 v[32:47], v[132:135], v[104:107], v[32:47]
    v_mfma_f32_32x32x16_bf16 v[48:63], v[132:135], v[108:111], v[48:63]
    buffer_load_dwordx4 v2, s[12:15], s57 offen offset:1024 sc1 lds
    ds_read_b128 v[104:107], v24 offset:5120
    ds_read_b128 v[108:111], v24 offset:37888
    s_waitcnt lgkmcnt(6)
    v_mfma_f32_32x32x16_bf16 v[32:47], v[136:139], v[112:115], v[32:47]
    v_mfma_f32_32x32x16_bf16 v[48:63], v[136:139], v[116:119], v[48:63]
    s_add_u32 m0, s58, 24576
    s_add_u32 s57, s57, 8192
    buffer_load_dwordx4 v2, s[12:15], s57 offen offset:0 sc1 lds
    ds_read_b128 v[112:115], v24 offset:6144
    ds_read_b128 v[116:119], v24 offset:38912
    s_waitcnt lgkmcnt(6)
    v_mfma_f32_32x32x16_bf16 v[32:47], v[140:143], v[120:123], v[32:47]
    v_mfma_f32_32x32x16_bf16 v[48:63], v[140:143], v[124:127], v[48:63]
    buffer_load_dwordx4 v2, s[12:15], s57 offen offset:1024 sc1 lds
    ds_read_b128 v[120:123], v24 offset:7168
    ds_read_b128 v[124:127], v24 offset:39936
    s_waitcnt lgkmcnt(6)
    v_mfma_f32_32x32x16_bf16 v[32:47], v[144:147], v[96:99], v[32:47]
    v_mfma_f32_32x32x16_bf16 v[48:63], v[144:147], v[100:103], v[48:63]
    buffer_load_dwordx4 v[128:131], v2, s[12:15], s78 offen offset:0 sc1
    s_waitcnt vmcnt(6)
    s_barrier
    ds_read_b128 v[96:99], v24 offset:8192
    ds_read_b128 v[100:103], v24 offset:40960
    s_waitcnt lgkmcnt(6)
    v_mfma_f32_32x32x16_bf16 v[32:47], v[148:151], v[104:107], v[32:47]
    v_mfma_f32_32x32x16_bf16 v[48:63], v[148:151], v[108:111], v[48:63]
    buffer_load_dwordx4 v[132:135], v2, s[12:15], s78 offen offset:1024 sc1
    ds_read_b128 v[104:107], v24 offset:9216
    ds_read_b128 v[108:111], v24 offset:41984
    s_waitcnt lgkmcnt(6)
    v_mfma_f32_32x32x16_bf16 v[32:47], v[152:155], v[112:115], v[32:47]
    v_mfma_f32_32x32x16_bf16 v[48:63], v[152:155], v[116:119], v[48:63]
    buffer_load_dwordx4 v[136:139], v2, s[12:15], s78 offen offset:2048 sc1
    ds_read_b128 v[112:115], v24 offset:10240
    ds_read_b128 v[116:119], v24 offset:43008
    s_waitcnt lgkmcnt(6)
    v_mfma_f32_32x32x16_bf16 v[32:47], v[156:159], v[120:123], v[32:47]
    v_mfma_f32_32x32x16_bf16 v[48:63], v[156:159], v[124:127], v[48:63]
    buffer_load_dwordx4 v[140:143], v2, s[12:15], s78 offen offset:3072 sc1
    ds_read_b128 v[120:123], v24 offset:11264
    ds_read_b128 v[124:127], v24 offset:44032
    s_waitcnt lgkmcnt(6)
    v_mfma_f32_32x32x16_bf16 v[32:47], v[160:163], v[96:99], v[32:47]
    v_mfma_f32_32x32x16_bf16 v[48:63], v[160:163], v[100:103], v[48:63]
    buffer_load_dwordx4 v[144:147], v2, s[12:15], s79 offen offset:0 sc1
    ds_read_b128 v[96:99], v24 offset:12288
    ds_read_b128 v[100:103], v24 offset:45056
    s_waitcnt lgkmcnt(6)
    v_mfma_f32_32x32x16_bf16 v[32:47], v[164:167], v[104:107], v[32:47]
    v_mfma_f32_32x32x16_bf16 v[48:63], v[164:167], v[108:111], v[48:63]
    buffer_load_dwordx4 v[148:151], v2, s[12:15], s79 offen offset:1024 sc1
    ds_read_b128 v[104:107], v24 offset:13312
    ds_read_b128 v[108:111], v24 offset:46080
    s_waitcnt lgkmcnt(6)
    v_mfma_f32_32x32x16_bf16 v[32:47], v[168:171], v[112:115], v[32:47]
    v_mfma_f32_32x32x16_bf16 v[48:63], v[168:171], v[116:119], v[48:63]
    buffer_load_dwordx4 v[152:155], v2, s[12:15], s79 offen offset:2048 sc1
    ds_read_b128 v[112:115], v24 offset:14336
    ds_read_b128 v[116:119], v24 offset:47104
    s_waitcnt lgkmcnt(6)
    v_mfma_f32_32x32x16_bf16 v[32:47], v[172:175], v[120:123], v[32:47]
    v_mfma_f32_32x32x16_bf16 v[48:63], v[172:175], v[124:127], v[48:63]
    buffer_load_dwordx4 v[156:159], v2, s[12:15], s79 offen offset:3072 sc1
    ds_read_b128 v[120:123], v24 offset:15360
    ds_read_b128 v[124:127], v24 offset:48128
    s_waitcnt lgkmcnt(6)
    v_mfma_f32_32x32x16_bf16 v[32:47], v[176:179], v[96:99], v[32:47]
    v_mfma_f32_32x32x16_bf16 v[48:63], v[176:179], v[100:103], v[48:63]
    buffer_load_dwordx4 v[160:163], v2, s[12:15], s80 offen offset:0 sc1
    s_waitcnt vmcnt(9)
    s_barrier
    ds_read_b128 v[96:99], v24 offset:16384
    ds_read_b128 v[100:103], v24 offset:49152
    s_waitcnt lgkmcnt(6)
    s_nop 0
    v_mfma_f32_32x32x16_bf16 v[32:47], v[180:183], v[104:107], v[32:47]
    buffer_load_dwordx4 v[88:91], v2, s[12:15], s54 offen offset:0 sc1
    buffer_load_dwordx4 v[92:95], v2, s[12:15], s54 offen offset:1024 sc1
    v_mfma_f32_32x32x16_bf16 v[48:63], v[180:183], v[108:111], v[48:63]
    buffer_load_dwordx4 v[164:167], v2, s[12:15], s80 offen offset:1024 sc1
    ds_read_b128 v[104:107], v24 offset:17408
    ds_read_b128 v[108:111], v24 offset:50176
    s_waitcnt lgkmcnt(6)
    v_mfma_f32_32x32x16_bf16 v[32:47], v[184:187], v[112:115], v[32:47]
    v_mfma_f32_32x32x16_bf16 v[48:63], v[184:187], v[116:119], v[48:63]
    buffer_load_dwordx4 v[168:171], v2, s[12:15], s80 offen offset:2048 sc1
    ds_read_b128 v[112:115], v24 offset:18432
    ds_read_b128 v[116:119], v24 offset:51200
    s_waitcnt lgkmcnt(6)
    v_mfma_f32_32x32x16_bf16 v[32:47], v[188:191], v[120:123], v[32:47]
    v_mfma_f32_32x32x16_bf16 v[48:63], v[188:191], v[124:127], v[48:63]
    buffer_load_dwordx4 v[172:175], v2, s[12:15], s80 offen offset:3072 sc1
    ds_read_b128 v[120:123], v24 offset:19456
    ds_read_b128 v[124:127], v24 offset:52224
    s_waitcnt lgkmcnt(6)
    v_mfma_f32_32x32x16_bf16 v[32:47], v[192:195], v[96:99], v[32:47]
    v_mfma_f32_32x32x16_bf16 v[48:63], v[192:195], v[100:103], v[48:63]
    buffer_load_dwordx4 v[176:179], v2, s[12:15], s81 offen offset:0 sc1
    ds_read_b128 v[96:99], v24 offset:20480
    ds_read_b128 v[100:103], v24 offset:53248
    s_waitcnt lgkmcnt(6)
    v_mfma_f32_32x32x16_bf16 v[32:47], v[196:199], v[104:107], v[32:47]
    v_mfma_f32_32x32x16_bf16 v[48:63], v[196:199], v[108:111], v[48:63]
    buffer_load_dwordx4 v[180:183], v2, s[12:15], s81 offen offset:1024 sc1
    ds_read_b128 v[104:107], v24 offset:21504
    ds_read_b128 v[108:111], v24 offset:54272
    s_waitcnt lgkmcnt(6)
    v_mfma_f32_32x32x16_bf16 v[32:47], v[200:203], v[112:115], v[32:47]
    v_mfma_f32_32x32x16_bf16 v[48:63], v[200:203], v[116:119], v[48:63]
    buffer_load_dwordx4 v[184:187], v2, s[12:15], s81 offen offset:2048 sc1
    ds_read_b128 v[112:115], v24 offset:22528
    ds_read_b128 v[116:119], v24 offset:55296
    s_waitcnt lgkmcnt(6)
    v_mfma_f32_32x32x16_bf16 v[32:47], v[204:207], v[120:123], v[32:47]
    v_mfma_f32_32x32x16_bf16 v[48:63], v[204:207], v[124:127], v[48:63]
    buffer_load_dwordx4 v[188:191], v2, s[12:15], s81 offen offset:3072 sc1
    ds_read_b128 v[120:123], v24 offset:23552
    ds_read_b128 v[124:127], v24 offset:56320
    s_waitcnt lgkmcnt(6)
    v_mfma_f32_32x32x16_bf16 v[32:47], v[208:211], v[96:99], v[32:47]
    v_mfma_f32_32x32x16_bf16 v[48:63], v[208:211], v[100:103], v[48:63]
    buffer_load_dwordx4 v[192:195], v2, s[12:15], s82 offen offset:0 sc1
    ds_read_b128 v[96:99], v24 offset:24576
    ds_read_b128 v[100:103], v24 offset:57344
    s_waitcnt lgkmcnt(6)
    v_mfma_f32_32x32x16_bf16 v[32:47], v[212:215], v[104:107], v[32:47]
    v_mfma_f32_32x32x16_bf16 v[48:63], v[212:215], v[108:111], v[48:63]
    buffer_load_dwordx4 v[196:199], v2, s[12:15], s82 offen offset:1024 sc1
    ds_read_b128 v[104:107], v24 offset:25600
    ds_read_b128 v[108:111], v24 offset:58368
    s_waitcnt lgkmcnt(6)
    v_mfma_f32_32x32x16_bf16 v[32:47], v[216:219], v[112:115], v[32:47]
    v_mfma_f32_32x32x16_bf16 v[48:63], v[216:219], v[116:119], v[48:63]
    buffer_load_dwordx4 v[200:203], v2, s[12:15], s82 offen offset:2048 sc1
    ds_read_b128 v[112:115], v24 offset:26624
    ds_read_b128 v[116:119], v24 offset:59392
    s_waitcnt lgkmcnt(6)
    v_mfma_f32_32x32x16_bf16 v[32:47], v[220:223], v[120:123], v[32:47]
    v_mfma_f32_32x32x16_bf16 v[48:63], v[220:223], v[124:127], v[48:63]
    buffer_load_dwordx4 v[204:207], v2, s[12:15], s82 offen offset:3072 sc1
    ds_read_b128 v[120:123], v24 offset:27648
    ds_read_b128 v[124:127], v24 offset:60416
    s_waitcnt lgkmcnt(6)
    v_mfma_f32_32x32x16_bf16 v[32:47], v[224:227], v[96:99], v[32:47]
    v_mfma_f32_32x32x16_bf16 v[48:63], v[224:227], v[100:103], v[48:63]
    buffer_load_dwordx4 v[208:211], v2, s[12:15], s83 offen offset:0 sc1
    ds_read_b128 v[96:99], v24 offset:28672
    ds_read_b128 v[100:103], v24 offset:61440
    s_waitcnt lgkmcnt(6)
    v_mfma_f32_32x32x16_bf16 v[32:47], v[228:231], v[104:107], v[32:47]
    v_mfma_f32_32x32x16_bf16 v[48:63], v[228:231], v[108:111], v[48:63]
    buffer_load_dwordx4 v[212:215], v2, s[12:15], s83 offen offset:1024 sc1
    ds_read_b128 v[104:107], v24 offset:29696
    ds_read_b128 v[108:111], v24 offset:62464
    s_waitcnt lgkmcnt(6)
    v_mfma_f32_32x32x16_bf16 v[32:47], v[232:235], v[112:115], v[32:47]
    v_mfma_f32_32x32x16_bf16 v[48:63], v[232:235], v[116:119], v[48:63]
    buffer_load_dwordx4 v[216:219], v2, s[12:15], s83 offen offset:2048 sc1
    ds_read_b128 v[112:115], v24 offset:30720
    ds_read_b128 v[116:119], v24 offset:63488
    s_waitcnt lgkmcnt(6)
    v_mfma_f32_32x32x16_bf16 v[32:47], v[236:239], v[120:123], v[32:47]
    s_waitcnt vmcnt(14)
    s_mov_b32 s101, 0
L_AGC:
    v_xor_b32 v91, s50, v91
    v_xor_b32 v95, s50, v95
    v_or_b32 v91, v91, v95
    v_cmp_ne_u32 vcc, 0, v91
    s_nop 0
    s_cbranch_vccnz L_AGR
L_AGK:
    v_mfma_f32_32x32x16_bf16 v[48:63], v[236:239], v[124:127], v[48:63]
    v_add_f32 v88, v88, v92
    v_add_f32 v89, v89, v93
    v_add_f32 v90, v90, v94
    v_mov_b32 v92, v88
    buffer_load_dwordx4 v[220:223], v2, s[12:15], s83 offen offset:3072 sc1
    ds_read_b128 v[120:123], v24 offset:31744
    ds_read_b128 v[124:127], v24 offset:64512
    s_waitcnt lgkmcnt(6)
    v_mfma_f32_32x32x16_bf16 v[32:47], v[240:243], v[96:99], v[32:47]
    v_mov_b32 v93, v89
    v_mov_b32_e64 v94, v90
    v_permlane32_swap_b32 v88, v92
    v_permlane32_swap_b32 v89, v93
    v_mfma_f32_32x32x16_bf16 v[48:63], v[240:243], v[100:103], v[48:63]
    v_permlane32_swap_b32 v90, v94
    v_add_f32 v88, v88, v92
    v_add_f32 v89, v89, v93
    v_add_f32 v90, v90, v94
    buffer_load_dwordx4 v[224:227], v2, s[12:15], s84 offen offset:0 sc1
    ds_read_b128 v[64:67], v21
    ds_read_b128 v[68:71], v21 offset:512
    ds_read_b128 v[80:83], v2 offset:0
    ds_read_b128 v[84:87], v2 offset:1024
    s_waitcnt lgkmcnt(8)
    v_mfma_f32_32x32x16_bf16 v[32:47], v[244:247], v[104:107], v[32:47]
    v_cvt_pk_bf16_f32 v95, v88, v88
    v_and_b32 v95, 0xffff0000, v95
    v_sub_f32 v92, v88, v95
    v_cvt_pk_bf16_f32 v95, v89, v89
    v_mfma_f32_32x32x16_bf16 v[48:63], v[244:247], v[108:111], v[48:63]
    v_and_b32 v95, 0xffff0000, v95
    v_sub_f32_e64 v93, v89, v95
    v_cvt_pk_bf16_f32 v95, v90, v90
    v_and_b32 v95, 0xffff0000, v95
    buffer_load_dwordx4 v[228:231], v2, s[12:15], s84 offen offset:1024 sc1
    s_waitcnt lgkmcnt(6)
    v_mfma_f32_32x32x16_bf16 v[32:47], v[248:251], v[112:115], v[32:47]
    v_sub_f32 v94, v90, v95
    v_cvt_pk_bf16_f32 v76, v88, v92
    v_cvt_pk_bf16_f32 v77, v88, v89
    v_cvt_pk_bf16_f32 v78, v93, v89
    v_mfma_f32_32x32x16_bf16 v[48:63], v[248:251], v[116:119], v[48:63]
    v_cvt_pk_bf16_f32 v79, v90, v94
    s_mov_b32 exec_lo, 0
    v_cvt_pk_bf16_f32 v76, v90, v11
    v_cvt_pk_bf16_f32 v77, v11, 0
    v_mov_b32 v78, 0
    v_mov_b32 v79, 0
    s_mov_b64 exec, -1
    buffer_load_dwordx4 v[232:235], v2, s[12:15], s84 offen offset:2048 sc1
    s_waitcnt lgkmcnt(4)
    v_mfma_f32_32x32x16_bf16 v[32:47], v[252:255], v[120:123], v[32:47]
    v_mfma_f32_32x32x16_bf16 v[48:63], v[252:255], v[124:127], v[48:63]
    buffer_load_dwordx4 v[236:239], v2, s[12:15], s84 offen offset:3072 sc1
    s_mov_b32 s101, 0
L_AUC:
    s_waitcnt lgkmcnt(0)
    v_xor_b32 v67, s50, v67
    v_xor_b32 v71, s50, v71
    v_or_b32 v67, v67, v71
    v_cmp_ne_u32_e64 vcc, 0, v67
    s_nop 0
    s_cbranch_vccnz L_AUR
L_AUK:
    v_mfma_f32_32x32x16_bf16 v[32:47], v[76:79], v[80:83], v[32:47]
    v_mfma_f32_32x32x16_bf16 v[48:63], v[76:79], v[84:87], v[48:63]
    v_mov_b32 v72, v65
    v_mov_b32 v74, v69
    s_setprio 0
    s_cmp_ge_u32 s40, 3
    s_cbranch_scc1 L_GELUPK
    s_nop 5
    v_mul_f32 v80, v32, v32
    v_mul_f32 v81, v33, v33
    v_mul_f32 v82, v34, v34
    v_mul_f32 v83, v35, v35
    v_mul_f32 v84, v36, v36
    v_mul_f32 v85, v37, v37
    v_mul_f32 v86, v38, v38
    v_mul_f32 v87, v39, v39
    v_mul_f32 v88, v40, v40
    v_mul_f32 v89, v41, v41
    v_mul_f32 v90, v42, v42
    v_mul_f32 v91, v43, v43
    v_mul_f32 v92, v44, v44
    v_mul_f32 v93, v45, v45
    v_mul_f32 v94, v46, v46
    v_mul_f32 v95, v47, v47
    v_fma_f32 v80, v80, v64, v66
    v_fma_f32 v81, v81, v64, v66
    v_fma_f32 v82, v82, v64, v66
    v_fma_f32 v83, v83, v64, v66
    v_fma_f32 v84, v84, v64, v66
    v_fma_f32 v85, v85, v64, v66
    v_fma_f32 v86, v86, v64, v66
    v_fma_f32 v87, v87, v64, v66
    v_fma_f32 v88, v88, v64, v66
    v_fma_f32 v89, v89, v64, v66
    v_fma_f32 v90, v90, v64, v66
    v_fma_f32 v91, v91, v64, v66
    v_fma_f32 v92, v92, v64, v66
    v_fma_f32 v93, v93, v64, v66
    v_fma_f32 v94, v94, v64, v66
    v_fma_f32 v95, v95, v64, v66
    v_mul_f32 v80, v80, v32
    v_mul_f32 v81, v81, v33
    v_mul_f32 v82, v82, v34
    v_mul_f32 v83, v83, v35
    v_mul_f32 v84, v84, v36
    v_mul_f32 v85, v85, v37
    v_mul_f32 v86, v86, v38
    v_mul_f32 v87, v87, v39
    v_mul_f32 v88, v88, v40
    v_mul_f32 v89, v89, v41
    v_mul_f32 v90, v90, v42
    v_mul_f32 v91, v91, v43
    v_mul_f32 v92, v92, v44
    v_mul_f32 v93, v93, v45
    v_mul_f32 v94, v94, v46
    v_mul_f32 v95, v95, v47
    v_exp_f32 v80, v80
    v_exp_f32 v81, v81
    v_exp_f32 v82, v82
    v_exp_f32 v83, v83
    v_exp_f32 v84, v84
    v_exp_f32 v85, v85
    v_exp_f32 v86, v86
    v_exp_f32 v87, v87
    v_exp_f32 v88, v88
    v_exp_f32 v89, v89
    v_exp_f32 v90, v90
    v_exp_f32 v91, v91
    v_exp_f32 v92, v92
    v_exp_f32 v93, v93
    v_exp_f32 v94, v94
    v_exp_f32 v95, v95
    v_fma_f32 v80, v80, v72, v72
    v_fma_f32 v81, v81, v72, v72
    v_fma_f32 v82, v82, v72, v72
    v_fma_f32 v83, v83, v72, v72
    v_fma_f32 v84, v84, v72, v72
    v_fma_f32 v85, v85, v72, v72
    v_fma_f32 v86, v86, v72, v72
    v_fma_f32 v87, v87, v72, v72
    v_fma_f32 v88, v88, v72, v72
    v_fma_f32 v89, v89, v72, v72
    v_fma_f32 v90, v90, v72, v72
    v_fma_f32 v91, v91, v72, v72
    v_fma_f32 v92, v92, v72, v72
    v_fma_f32 v93, v93, v72, v72
    v_fma_f32 v94, v94, v72, v72
    v_fma_f32 v95, v95, v72, v72
    v_rcp_f32 v80, v80
    v_rcp_f32 v81, v81
    v_rcp_f32 v82, v82
    v_rcp_f32 v83, v83
    v_rcp_f32 v84, v84
    v_rcp_f32 v85, v85
    v_rcp_f32 v86, v86
    v_rcp_f32 v87, v87
    v_rcp_f32 v88, v88
    v_rcp_f32 v89, v89
    v_rcp_f32 v90, v90
    v_rcp_f32 v91, v91
    v_rcp_f32 v92, v92
    v_rcp_f32 v93, v93
    v_rcp_f32 v94, v94
    v_rcp_f32 v95, v95
    v_mul_f32 v80, v80, v32
    v_mul_f32 v81, v81, v33
    v_mul_f32 v82, v82, v34
    v_mul_f32 v83, v83, v35
    v_mul_f32 v84, v84, v36
    v_mul_f32 v85, v85, v37
    v_mul_f32 v86, v86, v38
    v_mul_f32 v87, v87, v39
    v_mul_f32 v88, v88, v40
    v_mul_f32 v89, v89, v41
    v_mul_f32 v90, v90, v42
    v_mul_f32 v91, v91, v43
    v_mul_f32 v92, v92, v44
    v_mul_f32 v93, v93, v45
    v_mul_f32 v94, v94, v46
    v_mul_f32 v95, v95, v47
    v_cvt_pk_bf16_f32 v32, v80, v81
    v_cvt_pk_bf16_f32 v33, v82, v83
    v_cvt_pk_bf16_f32 v34, v84, v85
    v_cvt_pk_bf16_f32 v35, v86, v87
    v_cvt_pk_bf16_f32 v36, v88, v89
    v_cvt_pk_bf16_f32 v37, v90, v91
    v_cvt_pk_bf16_f32 v38, v92, v93
    v_cvt_pk_bf16_f32 v39, v94, v95
    buffer_store_dwordx4 v[32:35], v2, s[12:15], s52 offen sc1
    buffer_store_dwordx4 v[36:39], v2, s[12:15], s52 offen offset:1024 sc1
    ds_write_b128 v9, v[32:35] offset:0
    ds_write_b128 v9, v[36:39] offset:1024
    v_mul_f32 v80, v48, v48
    v_mul_f32 v81, v49, v49
    v_mul_f32 v82, v50, v50
    v_mul_f32 v83, v51, v51
    v_mul_f32 v84, v52, v52
    v_mul_f32 v85, v53, v53
    v_mul_f32 v86, v54, v54
    v_mul_f32 v87, v55, v55
    v_mul_f32 v88, v56, v56
    v_mul_f32 v89, v57, v57
    v_mul_f32 v90, v58, v58
    v_mul_f32 v91, v59, v59
    v_mul_f32 v92, v60, v60
    v_mul_f32 v93, v61, v61
    v_mul_f32 v94, v62, v62
    v_mul_f32 v95, v63, v63
    v_fma_f32 v80, v80, v68, v70
    v_fma_f32 v81, v81, v68, v70
    v_fma_f32 v82, v82, v68, v70
    v_fma_f32 v83, v83, v68, v70
    v_fma_f32 v84, v84, v68, v70
    v_fma_f32 v85, v85, v68, v70
    v_fma_f32 v86, v86, v68, v70
    v_fma_f32 v87, v87, v68, v70
    v_fma_f32 v88, v88, v68, v70
    v_fma_f32 v89, v89, v68, v70
    v_fma_f32 v90, v90, v68, v70
    v_fma_f32 v91, v91, v68, v70
    v_fma_f32 v92, v92, v68, v70
    v_fma_f32 v93, v93, v68, v70
    v_fma_f32 v94, v94, v68, v70
    v_fma_f32 v95, v95, v68, v70
    v_mul_f32 v80, v80, v48
    v_mul_f32 v81, v81, v49
    v_mul_f32 v82, v82, v50
    v_mul_f32 v83, v83, v51
    v_mul_f32 v84, v84, v52
    v_mul_f32 v85, v85, v53
    v_mul_f32 v86, v86, v54
    v_mul_f32 v87, v87, v55
    v_mul_f32 v88, v88, v56
    v_mul_f32 v89, v89, v57
    v_mul_f32 v90, v90, v58
    v_mul_f32 v91, v91, v59
    v_mul_f32 v92, v92, v60
    v_mul_f32 v93, v93, v61
    v_mul_f32 v94, v94, v62
    v_mul_f32 v95, v95, v63
    v_exp_f32 v80, v80
    v_exp_f32 v81, v81
    v_exp_f32 v82, v82
    v_exp_f32 v83, v83
    v_exp_f32 v84, v84
    v_exp_f32 v85, v85
    v_exp_f32 v86, v86
    v_exp_f32 v87, v87
    v_exp_f32 v88, v88
    v_exp_f32 v89, v89
    v_exp_f32 v90, v90
    v_exp_f32 v91, v91
    v_exp_f32 v92, v92
    v_exp_f32 v93, v93
    v_exp_f32 v94, v94
    v_exp_f32 v95, v95
    v_fma_f32 v80, v80, v74, v74
    v_fma_f32 v81, v81, v74, v74
    v_fma_f32 v82, v82, v74, v74
    v_fma_f32 v83, v83, v74, v74
    v_fma_f32 v84, v84, v74, v74
    v_fma_f32 v85, v85, v74, v74
    v_fma_f32 v86, v86, v74, v74
    v_fma_f32 v87, v87, v74, v74
    v_fma_f32 v88, v88, v74, v74
    v_fma_f32 v89, v89, v74, v74
    v_fma_f32 v90, v90, v74, v74
    v_fma_f32 v91, v91, v74, v74
    v_fma_f32 v92, v92, v74, v74
    v_fma_f32 v93, v93, v74, v74
    v_fma_f32 v94, v94, v74, v74
    v_fma_f32 v95, v95, v74, v74
    v_rcp_f32 v80, v80
    v_rcp_f32 v81, v81
    v_rcp_f32 v82, v82
    v_rcp_f32 v83, v83
    v_rcp_f32 v84, v84
    v_rcp_f32 v85, v85
    v_rcp_f32 v86, v86
    v_rcp_f32 v87, v87
    v_rcp_f32 v88, v88
    v_rcp_f32 v89, v89
    v_rcp_f32 v90, v90
    v_rcp_f32 v91, v91
    v_rcp_f32 v92, v92
    v_rcp_f32 v93, v93
    v_rcp_f32 v94, v94
    v_rcp_f32 v95, v95
    v_mul_f32 v80, v80, v48
    v_mul_f32 v81, v81, v49
    v_mul_f32 v82, v82, v50
    v_mul_f32 v83, v83, v51
    v_mul_f32 v84, v84, v52
    v_mul_f32 v85, v85, v53
    v_mul_f32 v86, v86, v54
    v_mul_f32 v87, v87, v55
    v_mul_f32 v88, v88, v56
    v_mul_f32 v89, v89, v57
    v_mul_f32 v90, v90, v58
    v_mul_f32 v91, v91, v59
    v_mul_f32 v92, v92, v60
    v_mul_f32 v93, v93, v61
    v_mul_f32 v94, v94, v62
    v_mul_f32 v95, v95, v63
    v_cvt_pk_bf16_f32 v48, v80, v81
    v_cvt_pk_bf16_f32 v49, v82, v83
    v_cvt_pk_bf16_f32 v50, v84, v85
    v_cvt_pk_bf16_f32 v51, v86, v87
    v_cvt_pk_bf16_f32 v52, v88, v89
    v_cvt_pk_bf16_f32 v53, v90, v91
    v_cvt_pk_bf16_f32 v54, v92, v93
    v_cvt_pk_bf16_f32 v55, v94, v95
    buffer_store_dwordx4 v[48:51], v2, s[12:15], s53 offen sc1
    buffer_store_dwordx4 v[52:55], v2, s[12:15], s53 offen offset:1024 sc1
    ds_write_b128 v9, v[48:51] offset:14336
    ds_write_b128 v9, v[52:55] offset:15360
    s_branch L_P5END
L_GELUPK:
    s_nop 5
    v_pk_mul_f32 v[80:81], v[32:33], v[32:33]
    v_pk_mul_f32 v[82:83], v[34:35], v[34:35]
    v_pk_mul_f32 v[84:85], v[36:37], v[36:37]
    v_pk_mul_f32 v[86:87], v[38:39], v[38:39]
    v_pk_mul_f32 v[88:89], v[40:41], v[40:41]
    v_pk_mul_f32 v[90:91], v[42:43], v[42:43]
    v_pk_mul_f32 v[92:93], v[44:45], v[44:45]
    v_pk_mul_f32 v[94:95], v[46:47], v[46:47]
    v_pk_fma_f32 v[80:81], v[80:81], v[64:65], v[66:67] op_sel_hi:[1,0,0]
    v_pk_fma_f32 v[82:83], v[82:83], v[64:65], v[66:67] op_sel_hi:[1,0,0]
    v_pk_fma_f32 v[84:85], v[84:85], v[64:65], v[66:67] op_sel_hi:[1,0,0]
    v_pk_fma_f32 v[86:87], v[86:87], v[64:65], v[66:67] op_sel_hi:[1,0,0]
    v_pk_fma_f32 v[88:89], v[88:89], v[64:65], v[66:67] op_sel_hi:[1,0,0]
    v_pk_fma_f32 v[90:91], v[90:91], v[64:65], v[66:67] op_sel_hi:[1,0,0]
    v_pk_fma_f32 v[92:93], v[92:93], v[64:65], v[66:67] op_sel_hi:[1,0,0]
    v_pk_fma_f32 v[94:95], v[94:95], v[64:65], v[66:67] op_sel_hi:[1,0,0]
    v_pk_mul_f32 v[80:81], v[80:81], v[32:33]
    v_pk_mul_f32 v[82:83], v[82:83], v[34:35]
    v_pk_mul_f32 v[84:85], v[84:85], v[36:37]
    v_pk_mul_f32 v[86:87], v[86:87], v[38:39]
    v_pk_mul_f32 v[88:89], v[88:89], v[40:41]
    v_pk_mul_f32 v[90:91], v[90:91], v[42:43]
    v_pk_mul_f32 v[92:93], v[92:93], v[44:45]
    v_pk_mul_f32 v[94:95], v[94:95], v[46:47]
    v_exp_f32 v80, v80
    v_exp_f32 v81, v81
    v_exp_f32 v82, v82
    v_exp_f32 v83, v83
    v_exp_f32 v84, v84
    v_exp_f32 v85, v85
    v_exp_f32 v86, v86
    v_exp_f32 v87, v87
    v_exp_f32 v88, v88
    v_exp_f32 v89, v89
    v_exp_f32 v90, v90
    v_exp_f32 v91, v91
    v_exp_f32 v92, v92
    v_exp_f32 v93, v93
    v_exp_f32 v94, v94
    v_exp_f32 v95, v95
    v_pk_fma_f32 v[80:81], v[80:81], v[72:73], v[72:73] op_sel_hi:[1,0,0]
    v_pk_fma_f32 v[82:83], v[82:83], v[72:73], v[72:73] op_sel_hi:[1,0,0]
    v_pk_fma_f32 v[84:85], v[84:85], v[72:73], v[72:73] op_sel_hi:[1,0,0]
    v_pk_fma_f32 v[86:87], v[86:87], v[72:73], v[72:73] op_sel_hi:[1,0,0]
    v_pk_fma_f32 v[88:89], v[88:89], v[72:73], v[72:73] op_sel_hi:[1,0,0]
    v_pk_fma_f32 v[90:91], v[90:91], v[72:73], v[72:73] op_sel_hi:[1,0,0]
    v_pk_fma_f32 v[92:93], v[92:93], v[72:73], v[72:73] op_sel_hi:[1,0,0]
    v_pk_fma_f32 v[94:95], v[94:95], v[72:73], v[72:73] op_sel_hi:[1,0,0]
    v_rcp_f32 v80, v80
    v_rcp_f32 v81, v81
    v_rcp_f32 v82, v82
    v_rcp_f32 v83, v83
    v_rcp_f32 v84, v84
    v_rcp_f32 v85, v85
    v_rcp_f32 v86, v86
    v_rcp_f32 v87, v87
    v_rcp_f32 v88, v88
    v_rcp_f32 v89, v89
    v_rcp_f32 v90, v90
    v_rcp_f32 v91, v91
    v_rcp_f32 v92, v92
    v_rcp_f32 v93, v93
    v_rcp_f32 v94, v94
    v_rcp_f32 v95, v95
    v_pk_mul_f32 v[80:81], v[80:81], v[32:33]
    v_pk_mul_f32 v[82:83], v[82:83], v[34:35]
    v_pk_mul_f32 v[84:85], v[84:85], v[36:37]
    v_pk_mul_f32 v[86:87], v[86:87], v[38:39]
    v_pk_mul_f32 v[88:89], v[88:89], v[40:41]
    v_pk_mul_f32 v[90:91], v[90:91], v[42:43]
    v_pk_mul_f32 v[92:93], v[92:93], v[44:45]
    v_pk_mul_f32 v[94:95], v[94:95], v[46:47]
    v_cvt_pk_bf16_f32 v32, v80, v81
    v_cvt_pk_bf16_f32 v33, v82, v83
    v_cvt_pk_bf16_f32 v34, v84, v85
    v_cvt_pk_bf16_f32 v35, v86, v87
    v_cvt_pk_bf16_f32 v36, v88, v89
    v_cvt_pk_bf16_f32 v37, v90, v91
    v_cvt_pk_bf16_f32 v38, v92, v93
    v_cvt_pk_bf16_f32 v39, v94, v95
    buffer_store_dwordx4 v[32:35], v2, s[12:15], s52 offen sc1
    buffer_store_dwordx4 v[36:39], v2, s[12:15], s52 offen offset:1024 sc1
    ds_write_b128 v9, v[32:35] offset:0
    ds_write_b128 v9, v[36:39] offset:1024
    v_pk_mul_f32 v[80:81], v[48:49], v[48:49]
    v_pk_mul_f32 v[82:83], v[50:51], v[50:51]
    v_pk_mul_f32 v[84:85], v[52:53], v[52:53]
    v_pk_mul_f32 v[86:87], v[54:55], v[54:55]
    v_pk_mul_f32 v[88:89], v[56:57], v[56:57]
    v_pk_mul_f32 v[90:91], v[58:59], v[58:59]
    v_pk_mul_f32 v[92:93], v[60:61], v[60:61]
    v_pk_mul_f32 v[94:95], v[62:63], v[62:63]
    v_pk_fma_f32 v[80:81], v[80:81], v[68:69], v[70:71] op_sel_hi:[1,0,0]
    v_pk_fma_f32 v[82:83], v[82:83], v[68:69], v[70:71] op_sel_hi:[1,0,0]
    v_pk_fma_f32 v[84:85], v[84:85], v[68:69], v[70:71] op_sel_hi:[1,0,0]
    v_pk_fma_f32 v[86:87], v[86:87], v[68:69], v[70:71] op_sel_hi:[1,0,0]
    v_pk_fma_f32 v[88:89], v[88:89], v[68:69], v[70:71] op_sel_hi:[1,0,0]
    v_pk_fma_f32 v[90:91], v[90:91], v[68:69], v[70:71] op_sel_hi:[1,0,0]
    v_pk_fma_f32 v[92:93], v[92:93], v[68:69], v[70:71] op_sel_hi:[1,0,0]
    v_pk_fma_f32 v[94:95], v[94:95], v[68:69], v[70:71] op_sel_hi:[1,0,0]
    v_pk_mul_f32 v[80:81], v[80:81], v[48:49]
    v_pk_mul_f32 v[82:83], v[82:83], v[50:51]
    v_pk_mul_f32 v[84:85], v[84:85], v[52:53]
    v_pk_mul_f32 v[86:87], v[86:87], v[54:55]
    v_pk_mul_f32 v[88:89], v[88:89], v[56:57]
    v_pk_mul_f32 v[90:91], v[90:91], v[58:59]
    v_pk_mul_f32 v[92:93], v[92:93], v[60:61]
    v_pk_mul_f32 v[94:95], v[94:95], v[62:63]
    v_exp_f32 v80, v80
    v_exp_f32 v81, v81
    v_exp_f32 v82, v82
    v_exp_f32 v83, v83
    v_exp_f32 v84, v84
    v_exp_f32 v85, v85
    v_exp_f32 v86, v86
    v_exp_f32 v87, v87
    v_exp_f32 v88, v88
    v_exp_f32 v89, v89
    v_exp_f32 v90, v90
    v_exp_f32 v91, v91
    v_exp_f32 v92, v92
    v_exp_f32 v93, v93
    v_exp_f32 v94, v94
    v_exp_f32 v95, v95
    v_pk_fma_f32 v[80:81], v[80:81], v[74:75], v[74:75] op_sel_hi:[1,0,0]
    v_pk_fma_f32 v[82:83], v[82:83], v[74:75], v[74:75] op_sel_hi:[1,0,0]
    v_pk_fma_f32 v[84:85], v[84:85], v[74:75], v[74:75] op_sel_hi:[1,0,0]
    v_pk_fma_f32 v[86:87], v[86:87], v[74:75], v[74:75] op_sel_hi:[1,0,0]
    v_pk_fma_f32 v[88:89], v[88:89], v[74:75], v[74:75] op_sel_hi:[1,0,0]
    v_pk_fma_f32 v[90:91], v[90:91], v[74:75], v[74:75] op_sel_hi:[1,0,0]
    v_pk_fma_f32 v[92:93], v[92:93], v[74:75], v[74:75] op_sel_hi:[1,0,0]
    v_pk_fma_f32 v[94:95], v[94:95], v[74:75], v[74:75] op_sel_hi:[1,0,0]
    v_rcp_f32 v80, v80
    v_rcp_f32 v81, v81
    v_rcp_f32 v82, v82
    v_rcp_f32 v83, v83
    v_rcp_f32 v84, v84
    v_rcp_f32 v85, v85
    v_rcp_f32 v86, v86
    v_rcp_f32 v87, v87
    v_rcp_f32 v88, v88
    v_rcp_f32 v89, v89
    v_rcp_f32 v90, v90
    v_rcp_f32 v91, v91
    v_rcp_f32 v92, v92
    v_rcp_f32 v93, v93
    v_rcp_f32 v94, v94
    v_rcp_f32 v95, v95
    v_pk_mul_f32 v[80:81], v[80:81], v[48:49]
    v_pk_mul_f32 v[82:83], v[82:83], v[50:51]
    v_pk_mul_f32 v[84:85], v[84:85], v[52:53]
    v_pk_mul_f32 v[86:87], v[86:87], v[54:55]
    v_pk_mul_f32 v[88:89], v[88:89], v[56:57]
    v_pk_mul_f32 v[90:91], v[90:91], v[58:59]
    v_pk_mul_f32 v[92:93], v[92:93], v[60:61]
    v_pk_mul_f32 v[94:95], v[94:95], v[62:63]
    v_cvt_pk_bf16_f32 v48, v80, v81
    v_cvt_pk_bf16_f32 v49, v82, v83
    v_cvt_pk_bf16_f32 v50, v84, v85
    v_cvt_pk_bf16_f32 v51, v86, v87
    v_cvt_pk_bf16_f32 v52, v88, v89
    v_cvt_pk_bf16_f32 v53, v90, v91
    v_cvt_pk_bf16_f32 v54, v92, v93
    v_cvt_pk_bf16_f32 v55, v94, v95
    buffer_store_dwordx4 v[48:51], v2, s[12:15], s53 offen sc1
    buffer_store_dwordx4 v[52:55], v2, s[12:15], s53 offen offset:1024 sc1
    ds_write_b128 v9, v[48:51] offset:14336
    ds_write_b128 v9, v[52:55] offset:15360
L_P5END:
    s_mul_i32 s57, s41, 917504
    s_mul_i32 s59, s48, 229376
    s_add_u32 s57, s57, s59
    s_mul_i32 s59, s40, 14336
    s_add_u32 s57, s57, s59
    s_add_u32 s57, s57, 14680064
    s_add_u32 s58, s57, 114688
    s_lshl_b32 s54, s40, 14
    v_and_b32 v21, 31, v1
    v_and_b32_e64 v22, 7, v1
    v_bfe_u32 v23, v1, 1, 1
    v_lshl_add_u32 v22, v23, 3, v22
    v_lshrrev_b32 v23, 5, v1
    v_xor_b32 v22, v22, v23
    v_lshlrev_b32_e64 v22, 4, v22
    v_lshl_add_u32 v4, v21, 8, v22
    v_add_u32 v4, s54, v4
    v_xor_b32 v5, 32, v4
    v_xor_b32_e64 v6, 64, v4
    v_xor_b32 v7, 96, v4
    v_xor_b32 v8, 128, v4
    v_xor_b32 v9, 160, v4
    v_xor_b32 v10, 192, v4
    v_xor_b32 v11, 224, v4
    v_and_b32 v22, 7, v1
    v_lshlrev_b32 v20, 5, v22
    v_add_u32 v20, 159744, v20
    v_add_u32 v21, 65536, v26
    v_add_u32 v24, 65536, v27
    s_lshl_b32 s53, s41, 12
    s_lshl_b32 s59, s48, 7
    s_add_u32 s53, s53, s59
    s_add_u32 s53, s53, 459392
    s_lshl_b32 s52, s49, 2
    s_add_u32 s52, s52, s53
    s_mov_b32 s53, s53
    s_lshl_b32 s59, s40, 2
    s_add_u32 s53, s53, s59
    v_mov_b32_e64 v28, s50
    s_mov_b32 s101, 0
    s_waitcnt vmcnt(0) lgkmcnt(0)
    s_barrier
    s_mov_b64 exec, 1
    s_cmp_eq_u32 s40, s49
    s_cbranch_scc1 L_P6OWN
L_HH_P:
    buffer_load_dword v30, v2, s[12:15], s53 offen sc1
    s_add_u32 s101, s101, 1
    s_cmp_gt_u32 s101, 131072
    s_cbranch_scc1 L_HH_X
    s_waitcnt vmcnt(0)
    v_cmp_ne_u32 vcc, s50, v30
    s_nop 0
    s_cbranch_vccnz L_HH_P
L_HH_X:
    s_mov_b64 exec, -1
    s_add_u32 s55, s57, 0
    buffer_load_dwordx4 v[96:99], v2, s[12:15], s55 offen offset:0 sc1
    buffer_load_dwordx4 v[100:103], v2, s[12:15], s55 offen offset:1024 sc1
    buffer_load_dwordx4 v[104:107], v2, s[12:15], s55 offen offset:2048 sc1
    buffer_load_dwordx4 v[108:111], v2, s[12:15], s55 offen offset:3072 sc1
    s_add_u32 s55, s57, 4096
    buffer_load_dwordx4 v[112:115], v2, s[12:15], s55 offen offset:0 sc1
    buffer_load_dwordx4 v[116:119], v2, s[12:15], s55 offen offset:1024 sc1
    buffer_load_dwordx4 v[120:123], v2, s[12:15], s55 offen offset:2048 sc1
    buffer_load_dwordx4 v[124:127], v2, s[12:15], s55 offen offset:3072 sc1
    s_add_u32 s55, s57, 8192
    buffer_load_dwordx4 v[240:243], v2, s[12:15], s55 offen offset:0 sc1
    buffer_load_dwordx4 v[244:247], v2, s[12:15], s55 offen offset:1024 sc1
    buffer_load_dwordx4 v[248:251], v2, s[12:15], s55 offen offset:2048 sc1
    buffer_load_dwordx4 v[252:255], v2, s[12:15], s55 offen offset:3072 sc1
    s_waitcnt vmcnt(11)
    v_mfma_f32_32x32x16_bf16 v[32:47], v[128:131], v[96:99], 0
    v_mfma_f32_32x32x16_bf16 v[48:63], v[132:135], v[96:99], 0
    s_add_u32 s55, s57, 12288
    buffer_load_dwordx4 v[96:99], v2, s[12:15], s55 offen offset:0 sc1
    s_waitcnt vmcnt(11)
    v_mfma_f32_32x32x16_bf16 v[32:47], v[136:139], v[100:103], v[32:47]
    v_mfma_f32_32x32x16_bf16 v[48:63], v[140:143], v[100:103], v[48:63]
    buffer_load_dwordx4 v[100:103], v2, s[12:15], s55 offen offset:1024 sc1
    s_waitcnt vmcnt(11)
    v_mfma_f32_32x32x16_bf16 v[32:47], v[144:147], v[104:107], v[32:47]
    v_mfma_f32_32x32x16_bf16 v[48:63], v[148:151], v[104:107], v[48:63]
    s_add_u32 s55, s58, 0
    buffer_load_dwordx4 v[104:107], v2, s[12:15], s55 offen offset:0 sc1
    s_waitcnt vmcnt(11)
    v_mfma_f32_32x32x16_bf16 v[32:47], v[152:155], v[108:111], v[32:47]
    v_mfma_f32_32x32x16_bf16 v[48:63], v[156:159], v[108:111], v[48:63]
    buffer_load_dwordx4 v[108:111], v2, s[12:15], s55 offen offset:1024 sc1
    s_waitcnt vmcnt(11)
    v_mfma_f32_32x32x16_bf16 v[32:47], v[160:163], v[112:115], v[32:47]
    v_mfma_f32_32x32x16_bf16 v[48:63], v[164:167], v[112:115], v[48:63]
    buffer_load_dwordx4 v[112:115], v2, s[12:15], s55 offen offset:2048 sc1
    s_waitcnt vmcnt(11)
    v_mfma_f32_32x32x16_bf16 v[32:47], v[168:171], v[116:119], v[32:47]
    v_mfma_f32_32x32x16_bf16 v[48:63], v[172:175], v[116:119], v[48:63]
    buffer_load_dwordx4 v[116:119], v2, s[12:15], s55 offen offset:3072 sc1
    s_waitcnt vmcnt(11)
    v_mfma_f32_32x32x16_bf16 v[32:47], v[176:179], v[120:123], v[32:47]
    v_mfma_f32_32x32x16_bf16 v[48:63], v[180:183], v[120:123], v[48:63]
    s_add_u32 s55, s58, 4096
    buffer_load_dwordx4 v[120:123], v2, s[12:15], s55 offen offset:0 sc1
    s_waitcnt vmcnt(11)
    v_mfma_f32_32x32x16_bf16 v[32:47], v[184:187], v[124:127], v[32:47]
    v_mfma_f32_32x32x16_bf16 v[48:63], v[188:191], v[124:127], v[48:63]
    buffer_load_dwordx4 v[124:127], v2, s[12:15], s55 offen offset:1024 sc1
    s_waitcnt vmcnt(11)
    v_mfma_f32_32x32x16_bf16 v[32:47], v[192:195], v[240:243], v[32:47]
    v_mfma_f32_32x32x16_bf16 v[48:63], v[196:199], v[240:243], v[48:63]
    buffer_load_dwordx4 v[240:243], v2, s[12:15], s55 offen offset:2048 sc1
    s_waitcnt vmcnt(11)
    v_mfma_f32_32x32x16_bf16 v[32:47], v[200:203], v[244:247], v[32:47]
    v_mfma_f32_32x32x16_bf16 v[48:63], v[204:207], v[244:247], v[48:63]
    buffer_load_dwordx4 v[244:247], v2, s[12:15], s55 offen offset:3072 sc1
    s_waitcnt vmcnt(11)
    v_mfma_f32_32x32x16_bf16 v[32:47], v[208:211], v[248:251], v[32:47]
    v_mfma_f32_32x32x16_bf16 v[48:63], v[212:215], v[248:251], v[48:63]
    s_add_u32 s55, s58, 8192
    buffer_load_dwordx4 v[248:251], v2, s[12:15], s55 offen offset:0 sc1
    s_waitcnt vmcnt(11)
    v_mfma_f32_32x32x16_bf16 v[32:47], v[216:219], v[252:255], v[32:47]
    v_mfma_f32_32x32x16_bf16 v[48:63], v[220:223], v[252:255], v[48:63]
    buffer_load_dwordx4 v[252:255], v2, s[12:15], s55 offen offset:1024 sc1
    s_waitcnt vmcnt(11)
    v_mfma_f32_32x32x16_bf16 v[32:47], v[224:227], v[96:99], v[32:47]
    v_mfma_f32_32x32x16_bf16 v[48:63], v[228:231], v[96:99], v[48:63]
    buffer_load_dwordx4 v[96:99], v2, s[12:15], s55 offen offset:2048 sc1
    s_waitcnt vmcnt(11)
    v_mfma_f32_32x32x16_bf16 v[32:47], v[232:235], v[100:103], v[32:47]
    v_mfma_f32_32x32x16_bf16 v[48:63], v[236:239], v[100:103], v[48:63]
    buffer_load_dwordx4 v[100:103], v2, s[12:15], s55 offen offset:3072 sc1
    s_waitcnt vmcnt(11)
    v_mfma_f32_32x32x16_bf16 v[64:79], v[128:131], v[104:107], 0
    v_mfma_f32_32x32x16_bf16 v[80:95], v[132:135], v[104:107], 0
    s_add_u32 s55, s58, 12288
    buffer_load_dwordx4 v[104:107], v2, s[12:15], s55 offen offset:0 sc1
    s_waitcnt vmcnt(11)
    v_mfma_f32_32x32x16_bf16 v[64:79], v[136:139], v[108:111], v[64:79]
    v_mfma_f32_32x32x16_bf16 v[80:95], v[140:143], v[108:111], v[80:95]
    buffer_load_dwordx4 v[108:111], v2, s[12:15], s55 offen offset:1024 sc1
    s_waitcnt vmcnt(11)
    v_mfma_f32_32x32x16_bf16 v[64:79], v[144:147], v[112:115], v[64:79]
    v_mfma_f32_32x32x16_bf16 v[80:95], v[148:151], v[112:115], v[80:95]
    s_waitcnt vmcnt(10)
    v_mfma_f32_32x32x16_bf16 v[64:79], v[152:155], v[116:119], v[64:79]
    v_mfma_f32_32x32x16_bf16 v[80:95], v[156:159], v[116:119], v[80:95]
    s_waitcnt vmcnt(9)
    v_mfma_f32_32x32x16_bf16 v[64:79], v[160:163], v[120:123], v[64:79]
    v_mfma_f32_32x32x16_bf16 v[80:95], v[164:167], v[120:123], v[80:95]
    ds_write_b128 v4, v[32:35] offset:0
    s_waitcnt vmcnt(8)
    v_mfma_f32_32x32x16_bf16 v[64:79], v[168:171], v[124:127], v[64:79]
    v_mfma_f32_32x32x16_bf16 v[80:95], v[172:175], v[124:127], v[80:95]
    ds_write_b128 v5, v[36:39] offset:0
    s_waitcnt vmcnt(7)
    v_mfma_f32_32x32x16_bf16 v[64:79], v[176:179], v[240:243], v[64:79]
    v_mfma_f32_32x32x16_bf16 v[80:95], v[180:183], v[240:243], v[80:95]
    ds_write_b128 v6, v[40:43] offset:0
    s_waitcnt vmcnt(6)
    v_mfma_f32_32x32x16_bf16 v[64:79], v[184:187], v[244:247], v[64:79]
    v_mfma_f32_32x32x16_bf16 v[80:95], v[188:191], v[244:247], v[80:95]
    ds_write_b128 v7, v[44:47] offset:0
    s_waitcnt vmcnt(5)
    v_mfma_f32_32x32x16_bf16 v[64:79], v[192:195], v[248:251], v[64:79]
    v_mfma_f32_32x32x16_bf16 v[80:95], v[196:199], v[248:251], v[80:95]
    ds_write_b128 v8, v[48:51] offset:0
    s_waitcnt vmcnt(4)
    v_mfma_f32_32x32x16_bf16 v[64:79], v[200:203], v[252:255], v[64:79]
    v_mfma_f32_32x32x16_bf16 v[80:95], v[204:207], v[252:255], v[80:95]
    ds_write_b128 v9, v[52:55] offset:0
    s_waitcnt vmcnt(3)
    v_mfma_f32_32x32x16_bf16 v[64:79], v[208:211], v[96:99], v[64:79]
    v_mfma_f32_32x32x16_bf16 v[80:95], v[212:215], v[96:99], v[80:95]
    ds_write_b128 v10, v[56:59] offset:0
    s_waitcnt vmcnt(2)
    v_mfma_f32_32x32x16_bf16 v[64:79], v[216:219], v[100:103], v[64:79]
    v_mfma_f32_32x32x16_bf16 v[80:95], v[220:223], v[100:103], v[80:95]
    ds_write_b128 v11, v[60:63] offset:0
    s_waitcnt vmcnt(1)
    v_mfma_f32_32x32x16_bf16 v[64:79], v[224:227], v[104:107], v[64:79]
    v_mfma_f32_32x32x16_bf16 v[80:95], v[228:231], v[104:107], v[80:95]
    s_waitcnt vmcnt(0)
    v_mfma_f32_32x32x16_bf16 v[64:79], v[232:235], v[108:111], v[64:79]
    v_mfma_f32_32x32x16_bf16 v[80:95], v[236:239], v[108:111], v[80:95]
L_P6J:
    ds_read_b128 v[112:115], v20 offset:768
    ds_read_b128 v[116:119], v20 offset:784
    s_waitcnt lgkmcnt(4)
    s_nop 7
    s_nop 0
    ds_write_b128 v4, v[64:67] offset:8192
    ds_write_b128 v5, v[68:71] offset:8192
    ds_write_b128 v6, v[72:75] offset:8192
    ds_write_b128 v7, v[76:79] offset:8192
    ds_write_b128 v8, v[80:83] offset:8192
    ds_write_b128 v9, v[84:87] offset:8192
    ds_write_b128 v10, v[88:91] offset:8192
    ds_write_b128 v11, v[92:95] offset:8192
    s_waitcnt lgkmcnt(0)
    s_barrier
    ds_read_b128 v[32:35], v26 offset:0
    ds_read_b128 v[36:39], v27 offset:0
    ds_read_b128 v[40:43], v26 offset:16384
    ds_read_b128 v[44:47], v27 offset:16384
    ds_read_b128 v[48:51], v26 offset:32768
    ds_read_b128 v[52:55], v27 offset:32768
    ds_read_b128 v[56:59], v26 offset:49152
    ds_read_b128 v[60:63], v27 offset:49152
    ds_read_b128 v[64:67], v21 offset:0
    ds_read_b128 v[68:71], v24 offset:0
    ds_read_b128 v[72:75], v21 offset:16384
    ds_read_b128 v[76:79], v24 offset:16384
    ds_read_b128 v[80:83], v21 offset:32768
    ds_read_b128 v[84:87], v24 offset:32768
    s_waitcnt lgkmcnt(10)
    s_nop 0
    ds_read_b128 v[88:91], v21 offset:49152
    ds_read_b128 v[92:95], v24 offset:49152
    v_pk_add_f32 v[32:33], v[32:33], v[40:41]
    v_pk_add_f32 v[34:35], v[34:35], v[42:43]
    v_pk_add_f32 v[36:37], v[36:37], v[44:45]
    v_pk_add_f32 v[38:39], v[38:39], v[46:47]
    s_waitcnt lgkmcnt(8)
    s_nop 0
    v_pk_add_f32 v[48:49], v[48:49], v[56:57]
    v_pk_add_f32 v[50:51], v[50:51], v[58:59]
    v_pk_add_f32 v[52:53], v[52:53], v[60:61]
    v_pk_add_f32 v[54:55], v[54:55], v[62:63]
    v_pk_add_f32 v[32:33], v[32:33], v[48:49]
    v_pk_add_f32 v[34:35], v[34:35], v[50:51]
    v_pk_add_f32 v[36:37], v[36:37], v[52:53]
    v_pk_add_f32 v[38:39], v[38:39], v[54:55]
    s_waitcnt lgkmcnt(4)
    s_nop 0
    v_pk_add_f32 v[64:65], v[64:65], v[72:73]
    v_pk_add_f32 v[66:67], v[66:67], v[74:75]
    v_pk_add_f32 v[68:69], v[68:69], v[76:77]
    v_pk_add_f32 v[70:71], v[70:71], v[78:79]
    v_pk_add_f32 v[32:33], v[32:33], v[64:65]
    v_pk_add_f32 v[34:35], v[34:35], v[66:67]
    v_pk_add_f32 v[36:37], v[36:37], v[68:69]
    v_pk_add_f32 v[38:39], v[38:39], v[70:71]
    s_waitcnt lgkmcnt(0)
    s_nop 0
    v_pk_add_f32 v[80:81], v[80:81], v[88:89]
    v_pk_add_f32 v[82:83], v[82:83], v[90:91]
    v_pk_add_f32 v[84:85], v[84:85], v[92:93]
    v_pk_add_f32 v[86:87], v[86:87], v[94:95]
    v_pk_add_f32 v[32:33], v[32:33], v[80:81]
    v_pk_add_f32 v[34:35], v[34:35], v[82:83]
    v_pk_add_f32 v[36:37], v[36:37], v[84:85]
    v_pk_add_f32 v[38:39], v[38:39], v[86:87]
    v_fmac_f32 v12, v112, v32
    v_fmac_f32 v13, v113, v36
    v_fmac_f32 v14, v114, v33
    v_fmac_f32 v15, v115, v37
    v_fmac_f32 v16, v116, v34
    v_fmac_f32 v17, v117, v38
    v_fmac_f32 v18, v118, v35
    v_fmac_f32 v19, v119, v39
    v_cvt_pk_bf16_f32 v40, v12, v13
    v_cvt_pk_bf16_f32 v41, v14, v15
    v_cvt_pk_bf16_f32 v42, v16, v17
    v_cvt_pk_bf16_f32 v43, v18, v19
    buffer_store_dwordx4 v[40:43], v25, s[36:39], s98 offen sc1
L_END:
    s_endpgm
L_REGRT:
    s_nop 4
    s_add_u32 s101, s101, 1
    s_cmp_gt_u32 s101, 131072
    s_cbranch_scc1 L_REGOK
    s_sleep 4
    buffer_load_dword v24, v27, s[12:15], 0 offen sc1
    s_waitcnt vmcnt(0)
    s_branch L_REGC
SLOW_6:
    s_nop 4
    buffer_store_dwordx4 v[136:139], v2, s[12:15], s54 offen sc1
    buffer_store_dwordx4 v[140:143], v2, s[12:15], s54 offen offset:16 sc1
    s_nop 1
    s_branch JOIN_7
L_P2X8:
    s_nop 4
    v_mfma_f32_32x32x16_bf16 v[80:95], v[116:119], v[100:103], v[80:95]
    s_branch L_P2T8
L_P2X7:
    s_nop 4
    v_mfma_f32_32x32x16_bf16 v[80:95], v[124:127], v[100:103], v[80:95]
    s_branch L_P2T7
L_P2X6:
    s_nop 4
    v_mfma_f32_32x32x16_bf16 v[80:95], v[116:119], v[100:103], v[80:95]
    s_branch L_P2T6
L_P2X5:
    s_nop 4
    v_mfma_f32_32x32x16_bf16 v[80:95], v[124:127], v[100:103], v[80:95]
    s_branch L_P2T5
L_P2X4:
    s_nop 4
    v_mfma_f32_32x32x16_bf16 v[80:95], v[116:119], v[100:103], v[80:95]
    s_branch L_P2T4
L_P2X3:
    s_nop 4
    v_mfma_f32_32x32x16_bf16 v[80:95], v[124:127], v[100:103], v[80:95]
    s_branch L_P2T3
L_P2X2:
    s_nop 4
    v_mfma_f32_32x32x16_bf16 v[80:95], v[116:119], v[100:103], v[80:95]
    s_branch L_P2T2
L_P2X1:
    s_nop 4
    v_mfma_f32_32x32x16_bf16 v[80:95], v[124:127], v[100:103], v[80:95]
    s_branch L_P2T1
L_P2TAIL:
    s_nop 4
L_P2T8:
    s_nop 0
    buffer_load_dwordx4 v[144:147], v2, s[12:15], s71 offen offset:0 sc1
    buffer_load_dwordx4 v[148:151], v2, s[12:15], s71 offen offset:1024 sc1
    buffer_load_dwordx4 v[152:155], v2, s[12:15], s71 offen offset:2048 sc1
    buffer_load_dwordx4 v[156:159], v2, s[12:15], s71 offen offset:3072 sc1
L_P2T7:
    buffer_load_dwordx4 v[160:163], v2, s[12:15], s72 offen offset:0 sc1
    buffer_load_dwordx4 v[164:167], v2, s[12:15], s72 offen offset:1024 sc1
    buffer_load_dwordx4 v[168:171], v2, s[12:15], s72 offen offset:2048 sc1
L_P2T6:
    buffer_load_dwordx4 v[172:175], v2, s[12:15], s72 offen offset:3072 sc1
    buffer_load_dwordx4 v[176:179], v2, s[12:15], s73 offen offset:0 sc1
    buffer_load_dwordx4 v[180:183], v2, s[12:15], s73 offen offset:1024 sc1
L_P2T5:
    buffer_load_dwordx4 v[184:187], v2, s[12:15], s73 offen offset:2048 sc1
    buffer_load_dwordx4 v[188:191], v2, s[12:15], s73 offen offset:3072 sc1
    buffer_load_dwordx4 v[192:195], v2, s[12:15], s74 offen offset:0 sc1
L_P2T4:
    buffer_load_dwordx4 v[196:199], v2, s[12:15], s74 offen offset:1024 sc1
    buffer_load_dwordx4 v[200:203], v2, s[12:15], s74 offen offset:2048 sc1
    buffer_load_dwordx4 v[204:207], v2, s[12:15], s74 offen offset:3072 sc1
L_P2T3:
L_P2T2:
L_P2T1:
    s_nop 7
    s_nop 3
    s_branch L_P2E
SLOW_8:
    s_nop 4
    buffer_store_dwordx4 v[40:43], v2, s[12:15], s54 offen sc1
    buffer_store_dwordx4 v[44:47], v2, s[12:15], s54 offen offset:16 sc1
    s_nop 1
    s_branch JOIN_9
L_PREPLATE:
    s_nop 4
    s_cmp_eq_u32 s68, 1
    s_cbranch_scc1 L_PREPLA2
    v_lshrrev_b32 v52, 5, v1
    v_sub_u32 v53, 1, v52
    v_lshlrev_b32 v53, 13, v53
    v_bfe_u32 v54, v1, 4, 1
    v_lshl_add_u32 v53, v54, 10, v53
    v_and_b32_e64 v54, 15, v1
    v_lshl_add_u32 v53, v54, 4, v53
    s_lshl_b32 s58, s48, 11
    s_add_u32 s58, s58, 90112
    s_mov_b32 s101, 0
    s_mov_b32 s56, 0x0c0c0400
    s_mov_b32 s57, 0x04000c0c
L_P3LC:
    buffer_load_dwordx4 v[32:35], v53, s[12:15], s58 offen offset:0 sc1
    buffer_load_dwordx4 v[36:39], v53, s[12:15], s58 offen offset:256 sc1
    buffer_load_dwordx4 v[40:43], v53, s[12:15], s58 offen offset:512 sc1
    buffer_load_dwordx4 v[44:47], v53, s[12:15], s58 offen offset:768 sc1
    s_add_u32 s101, s101, 1
    s_cmp_gt_u32 s101, 131072
    s_cbranch_scc1 L_P3LK
    s_waitcnt vmcnt(0)
    s_nop 0
    v_perm_b32 v48, v33, v32, s56
    v_perm_b32 v49, v35, v34, s57
    v_bitop3_b32 v50, v48, v49, s50 bitop3:0x56
    v_perm_b32 v48, v37, v36, s56
    v_perm_b32 v49, v39, v38, s57
    v_bitop3_b32 v48, v48, v49, s50 bitop3:0x56
    v_or_b32_e64 v50, v50, v48
    v_perm_b32 v48, v41, v40, s56
    v_perm_b32 v49, v43, v42, s57
    v_bitop3_b32 v48, v48, v49, s50 bitop3:0x56
    v_or_b32_e64 v50, v50, v48
    v_perm_b32 v48, v45, v44, s56
    v_perm_b32 v49, v47, v46, s57
    v_bitop3_b32 v48, v48, v49, s50 bitop3:0x56
    v_or_b32 v50, v50, v48
    v_cmp_ne_u32 vcc, 0, v50
    s_nop 0
    s_cbranch_vccnz L_P3LC
L_P3LK:
    v_mov_b32 v48, 0xffffff00
    v_and_b32 v32, v48, v32
    v_and_b32 v33, v48, v33
    v_and_b32 v34, v48, v34
    v_and_b32 v35, v48, v35
    v_and_b32 v36, v48, v36
    v_and_b32 v37, v48, v37
    v_and_b32 v38, v48, v38
    v_and_b32 v39, v48, v39
    v_and_b32 v40, v48, v40
    v_and_b32 v41, v48, v41
    v_and_b32 v42, v48, v42
    v_and_b32 v43, v48, v43
    v_and_b32 v44, v48, v44
    v_and_b32 v45, v48, v45
    v_and_b32 v46, v48, v46
    v_and_b32 v47, v48, v47
    v_pk_add_f32 v[32:33], v[32:33], v[36:37]
    v_pk_add_f32 v[40:41], v[40:41], v[44:45]
    v_pk_add_f32 v[34:35], v[34:35], v[38:39]
    v_pk_add_f32 v[42:43], v[42:43], v[46:47]
    v_pk_add_f32 v[32:33], v[32:33], v[40:41]
    v_pk_add_f32 v[34:35], v[34:35], v[42:43]
    v_cvt_pk_bf16_f32 v36, v32, v33
    v_lshlrev_b32_e64 v32, 16, v36
    v_and_b32 v33, 0xffff0000, v36
    v_cvt_pk_bf16_f32 v38, v34, v35
    v_lshlrev_b32_e64 v34, 16, v38
    v_and_b32 v35, 0xffff0000, v38
    v_sub_u32 v52, 1, v52
    v_cvt_f32_u32 v52, v52
    v_add_f32 v32, v52, v32
    v_add_f32 v33, v52, v33
    v_add_f32 v34, v52, v34
    v_add_f32 v35, v52, v35
    v_cvt_pk_bf16_f32 v36, v32, v33
    v_cvt_pk_bf16_f32 v37, v34, v35
    v_lshlrev_b32_e64 v53, 3, v1
    v_add_u32 v53, 162048, v53
    ds_write_b64 v53, v[36:37]
    v_lshlrev_b32_e64 v54, 2, v1
    v_add_u32 v54, 162560, v54
    v_mov_b32 v38, 0x3f803f80
    ds_write_b32 v54, v38
    s_waitcnt lgkmcnt(0)
    s_branch L_PREPLR
L_PREPLA2:
    s_mul_i32 s56, s49, 7
    v_lshrrev_b32 v56, 5, v1
    v_add_u32 v56, s56, v56
    v_and_b32 v57, 1, v56
    v_lshrrev_b32 v56, 1, v56
    v_lshlrev_b32 v56, 7, v56
    v_lshl_add_u32 v56, v57, 1, v56
    v_and_b32_e64 v57, 31, v1
    v_lshl_add_u32 v56, v57, 2, v56
    buffer_load_ushort v59, v56, s[28:31], 0 offen offset:0
    buffer_load_ushort v60, v56, s[28:31], 0 offen offset:128
    buffer_load_ushort v61, v56, s[28:31], 0 offen offset:256
    buffer_load_ushort v62, v56, s[28:31], 0 offen offset:384
    v_lshlrev_b32 v57, 1, v1
    s_lshl_b32 s55, s49, 7
    buffer_load_ushort v58, v57, s[32:35], s55 offen
    v_lshrrev_b32 v52, 4, v1
    v_lshlrev_b32 v53, 13, v52
    v_and_b32_e64 v54, 15, v1
    v_lshl_add_u32 v53, v54, 4, v53
    s_lshl_b32 s58, s49, 10
    s_add_u32 s58, s58, 81920
    s_mov_b32 s101, 0
    s_mov_b32 s56, 0x0c0c0400
    s_mov_b32 s57, 0x04000c0c
L_PRLC:
    buffer_load_dwordx4 v[32:35], v53, s[12:15], s58 offen offset:0 sc1
    buffer_load_dwordx4 v[36:39], v53, s[12:15], s58 offen offset:256 sc1
    buffer_load_dwordx4 v[40:43], v53, s[12:15], s58 offen offset:512 sc1
    buffer_load_dwordx4 v[44:47], v53, s[12:15], s58 offen offset:768 sc1
    s_add_u32 s101, s101, 1
    s_cmp_gt_u32 s101, 131072
    s_cbranch_scc1 L_PRLK
    s_waitcnt vmcnt(0)
    s_nop 0
    v_perm_b32 v48, v33, v32, s56
    v_perm_b32 v49, v35, v34, s57
    v_bitop3_b32 v50, v48, v49, s50 bitop3:0x56
    v_perm_b32 v48, v37, v36, s56
    v_perm_b32 v49, v39, v38, s57
    v_bitop3_b32 v48, v48, v49, s50 bitop3:0x56
    v_or_b32_e64 v50, v50, v48
    v_perm_b32 v48, v41, v40, s56
    v_perm_b32 v49, v43, v42, s57
    v_bitop3_b32 v48, v48, v49, s50 bitop3:0x56
    v_or_b32_e64 v50, v50, v48
    v_perm_b32 v48, v45, v44, s56
    v_perm_b32 v49, v47, v46, s57
    v_bitop3_b32 v48, v48, v49, s50 bitop3:0x56
    v_or_b32 v50, v50, v48
    v_cmp_ne_u32 vcc, 0, v50
    s_nop 0
    s_cbranch_vccnz L_PRLC
L_PRLK:
    v_mov_b32 v48, 0xffffff00
    v_and_b32 v32, v48, v32
    v_and_b32 v33, v48, v33
    v_and_b32 v34, v48, v34
    v_and_b32 v35, v48, v35
    v_and_b32 v36, v48, v36
    v_and_b32 v37, v48, v37
    v_and_b32 v38, v48, v38
    v_and_b32 v39, v48, v39
    v_and_b32 v40, v48, v40
    v_and_b32 v41, v48, v41
    v_and_b32 v42, v48, v42
    v_and_b32 v43, v48, v43
    v_and_b32 v44, v48, v44
    v_and_b32 v45, v48, v45
    v_and_b32 v46, v48, v46
    v_and_b32 v47, v48, v47
    v_pk_add_f32 v[32:33], v[32:33], v[36:37]
    v_pk_add_f32 v[40:41], v[40:41], v[44:45]
    v_pk_add_f32 v[34:35], v[34:35], v[38:39]
    v_pk_add_f32 v[42:43], v[42:43], v[46:47]
    v_pk_add_f32 v[32:33], v[32:33], v[40:41]
    v_pk_add_f32 v[34:35], v[34:35], v[42:43]
    v_cvt_pk_bf16_f32 v36, v32, v33
    v_lshlrev_b32_e64 v32, 16, v36
    v_and_b32 v33, 0xffff0000, v36
    v_cvt_pk_bf16_f32 v38, v34, v35
    v_lshlrev_b32_e64 v34, 16, v38
    v_and_b32 v35, 0xffff0000, v38
    v_cmp_eq_u32 s[90:91], 2, v52
    s_nop 1
    v_cndmask_b32 v52, 0, 1.0, s[90:91]
    v_add_f32 v32, v52, v32
    v_add_f32 v33, v52, v33
    v_add_f32 v34, v52, v34
    v_add_f32_e64 v35, v52, v35
    v_cvt_pk_bf16_f32 v36, v32, v33
    v_lshlrev_b32_e64 v32, 16, v36
    v_and_b32 v33, 0xffff0000, v36
    v_cvt_pk_bf16_f32 v38, v34, v35
    v_lshlrev_b32_e64 v34, 16, v38
    v_and_b32 v35, 0xffff0000, v38
    v_add_u32 v53, 159744, v2
    ds_write_b128 v53, v[32:35]
    v_lshlrev_b32_e64 v56, 2, v1
    v_add_u32 v56, 159744, v56
    ds_read_b32 v40, v56 offset:512
    ds_read_b32 v44, v56 offset:256
    v_lshlrev_b32_e64 v58, 16, v58
    ds_write_b32 v56, v58 offset:1024
    v_lshlrev_b32_e64 v59, 16, v59
    ds_write_b32 v56, v59 offset:1280
    v_lshlrev_b32_e64 v60, 16, v60
    ds_write_b32 v56, v60 offset:1536
    v_lshlrev_b32_e64 v61, 16, v61
    ds_write_b32 v56, v61 offset:1792
    v_lshlrev_b32_e64 v62, 16, v62
    ds_write_b32 v56, v62 offset:2048
    s_waitcnt lgkmcnt(0)
    v_mul_f32 v41, v40, v40
    v_mul_f32 v42, v40, v44
    v_mul_f32 v45, v44, v44
    v_add_f32_dpp v40, v40, v40 quad_perm:[1,0,3,2] row_mask:0xf bank_mask:0xf
    v_add_f32_dpp v41, v41, v41 quad_perm:[1,0,3,2] row_mask:0xf bank_mask:0xf
    v_add_f32_dpp v42, v42, v42 quad_perm:[1,0,3,2] row_mask:0xf bank_mask:0xf
    v_add_f32_dpp v44, v44, v44 quad_perm:[1,0,3,2] row_mask:0xf bank_mask:0xf
    v_add_f32_dpp v45, v45, v45 quad_perm:[1,0,3,2] row_mask:0xf bank_mask:0xf
    v_add_f32_dpp v40, v40, v40 quad_perm:[2,3,0,1] row_mask:0xf bank_mask:0xf
    v_add_f32_dpp v41, v41, v41 quad_perm:[2,3,0,1] row_mask:0xf bank_mask:0xf
    v_add_f32_dpp v42, v42, v42 quad_perm:[2,3,0,1] row_mask:0xf bank_mask:0xf
    v_add_f32_dpp v44, v44, v44 quad_perm:[2,3,0,1] row_mask:0xf bank_mask:0xf
    v_add_f32_dpp v45, v45, v45 quad_perm:[2,3,0,1] row_mask:0xf bank_mask:0xf
    v_add_f32_dpp v40, v40, v40 row_ror:4 row_mask:0xf bank_mask:0xf
    v_add_f32_dpp v41, v41, v41 row_ror:4 row_mask:0xf bank_mask:0xf
    v_add_f32_dpp v42, v42, v42 row_ror:4 row_mask:0xf bank_mask:0xf
    v_add_f32_dpp v44, v44, v44 row_ror:4 row_mask:0xf bank_mask:0xf
    v_add_f32_dpp v45, v45, v45 row_ror:4 row_mask:0xf bank_mask:0xf
    v_add_f32_dpp v40, v40, v40 row_ror:8 row_mask:0xf bank_mask:0xf
    v_add_f32_dpp v41, v41, v41 row_ror:8 row_mask:0xf bank_mask:0xf
    v_add_f32_dpp v42, v42, v42 row_ror:8 row_mask:0xf bank_mask:0xf
    v_add_f32_dpp v44, v44, v44 row_ror:8 row_mask:0xf bank_mask:0xf
    v_add_f32_dpp v45, v45, v45 row_ror:8 row_mask:0xf bank_mask:0xf
    v_mov_b32 v48, v40
    v_mov_b32 v49, v41
    v_mov_b32 v50, v42
    v_mov_b32 v52, v44
    v_mov_b32 v53, v45
    v_permlane16_swap_b32 v40, v48
    v_permlane16_swap_b32 v41, v49
    v_permlane16_swap_b32 v42, v50
    v_permlane16_swap_b32 v44, v52
    v_permlane16_swap_b32 v45, v53
    v_add_f32 v40, v40, v48
    v_add_f32 v41, v41, v49
    v_add_f32 v42, v42, v50
    v_add_f32 v44, v44, v52
    v_add_f32 v45, v45, v53
    v_mov_b32 v48, v40
    v_mov_b32 v49, v41
    v_mov_b32 v50, v42
    v_mov_b32 v52, v44
    v_mov_b32 v53, v45
    v_permlane32_swap_b32 v40, v48
    v_permlane32_swap_b32 v41, v49
    v_permlane32_swap_b32 v42, v50
    v_permlane32_swap_b32 v44, v52
    v_permlane32_swap_b32 v45, v53
    v_add_f32 v40, v40, v48
    v_add_f32 v41, v41, v49
    v_add_f32 v42, v42, v50
    v_add_f32 v44, v44, v52
    v_add_f32 v45, v45, v53
    v_mov_b32 v43, s50
    v_mov_b32 v47, s50
    v_mov_b32 v46, 0
    s_lshl_b32 s54, s41, 12
    s_lshl_b32 s59, s48, 8
    s_add_u32 s54, s54, s59
    s_lshl_b32 s59, s49, 5
    s_add_u32 s54, s54, s59
    s_add_u32 s54, s54, 459904
    s_mov_b64 exec, 1
    s_cmp_eq_u32 s51, 0
    s_cbranch_scc1 SLOW_8
    buffer_store_dwordx4 v[40:43], v2, s[12:15], s54 offen
    buffer_store_dwordx4 v[44:47], v2, s[12:15], s54 offen offset:16
JOIN_9:
    s_mov_b64 exec, -1
    s_branch L_PREPLR
SLOW_10:
    s_nop 4
    buffer_store_dword v28, v29, s[12:15], s52 offen sc1
    s_nop 1
    s_branch JOIN_11
SLOW_12:
    s_nop 4
    buffer_store_dword v28, v29, s[12:15], s52 offen sc1
    s_nop 1
    s_branch JOIN_13
L_P5W7:
    s_nop 4
    s_waitcnt vmcnt(2) lgkmcnt(0)
    s_barrier
    s_add_u32 m0, s58, 16384
    s_add_u32 s57, s57, 8192
    buffer_load_dwordx4 v2, s[12:15], s57 offen offset:0 sc1 lds
    buffer_load_dwordx4 v2, s[12:15], s57 offen offset:1024 sc1 lds
    s_add_u32 m0, s58, 24576
    s_add_u32 s57, s57, 8192
    buffer_load_dwordx4 v2, s[12:15], s57 offen offset:0 sc1 lds
    buffer_load_dwordx4 v2, s[12:15], s57 offen offset:1024 sc1 lds
    s_lshl_b32 s52, s41, 16
    s_lshl_b32 s59, s48, 14
    s_add_u32 s52, s52, s59
    s_add_u32 s52, s52, 524288
    s_lshl_b32 s55, s41, 12
    s_lshl_b32 s59, s48, 8
    s_add_u32 s55, s55, s59
    s_add_u32 s55, s55, 459904
    v_and_b32 v23, 7, v1
    v_lshlrev_b32 v23, 5, v23
    buffer_load_dwordx4 v[32:35], v2, s[12:15], s52 offen offset:0 sc1
    buffer_load_dwordx4 v[36:39], v2, s[12:15], s52 offen offset:1024 sc1
    buffer_load_dwordx4 v[40:43], v2, s[12:15], s52 offen offset:2048 sc1
    buffer_load_dwordx4 v[44:47], v2, s[12:15], s52 offen offset:3072 sc1
    s_add_u32 s52, s52, 4096
    buffer_load_dwordx4 v[48:51], v2, s[12:15], s52 offen offset:0 sc1
    buffer_load_dwordx4 v[52:55], v2, s[12:15], s52 offen offset:1024 sc1
    buffer_load_dwordx4 v[56:59], v2, s[12:15], s52 offen offset:2048 sc1
    buffer_load_dwordx4 v[60:63], v2, s[12:15], s52 offen offset:3072 sc1
    s_add_u32 s52, s52, 4096
    buffer_load_dwordx4 v[64:67], v2, s[12:15], s52 offen offset:0 sc1
    buffer_load_dwordx4 v[68:71], v2, s[12:15], s52 offen offset:1024 sc1
    buffer_load_dwordx4 v[72:75], v2, s[12:15], s52 offen offset:2048 sc1
    buffer_load_dwordx4 v[76:79], v2, s[12:15], s52 offen offset:3072 sc1
    s_add_u32 s52, s52, 4096
    buffer_load_dwordx4 v[80:83], v2, s[12:15], s52 offen offset:0 sc1
    buffer_load_dwordx4 v[84:87], v2, s[12:15], s52 offen offset:1024 sc1
    buffer_load_dwordx4 v[88:91], v2, s[12:15], s52 offen offset:2048 sc1
    buffer_load_dwordx4 v[92:95], v2, s[12:15], s52 offen offset:3072 sc1
    buffer_load_dwordx4 v[96:99], v23, s[12:15], s55 offen sc1
    buffer_load_dwordx4 v[100:103], v23, s[12:15], s55 offen offset:16 sc1
    s_waitcnt vmcnt(22)
    s_barrier
    s_waitcnt vmcnt(18)
    s_barrier
    s_waitcnt vmcnt(0)
    s_setprio 2
    s_mov_b32 s101, 0
L_COC:
    v_xor_b32 v99, s50, v99
    v_xor_b32 v103, s50, v103
    v_or_b32 v99, v99, v103
    v_cmp_ne_u32 vcc, 0, v99
    s_nop 0
    s_cbranch_vccz L_COK
    s_add_u32 s101, s101, 1
    s_cmp_gt_u32 s101, 131072
    s_cbranch_scc1 L_COK
    buffer_load_dwordx4 v[96:99], v23, s[12:15], s55 offen sc1
    buffer_load_dwordx4 v[100:103], v23, s[12:15], s55 offen offset:16 sc1
    s_waitcnt vmcnt(0)
    s_branch L_COC
L_COK:
    s_nop 0
    v_add_f32_dpp v96, v96, v96 quad_perm:[1,0,3,2] row_mask:0xf bank_mask:0xf
    v_add_f32_dpp v97, v97, v97 quad_perm:[1,0,3,2] row_mask:0xf bank_mask:0xf
    v_add_f32_dpp v98, v98, v98 quad_perm:[1,0,3,2] row_mask:0xf bank_mask:0xf
    v_add_f32_dpp v100, v100, v100 quad_perm:[1,0,3,2] row_mask:0xf bank_mask:0xf
    v_add_f32_dpp v101, v101, v101 quad_perm:[1,0,3,2] row_mask:0xf bank_mask:0xf
    v_add_f32_dpp v96, v96, v96 quad_perm:[2,3,0,1] row_mask:0xf bank_mask:0xf
    v_add_f32_dpp v97, v97, v97 quad_perm:[2,3,0,1] row_mask:0xf bank_mask:0xf
    v_add_f32_dpp v98, v98, v98 quad_perm:[2,3,0,1] row_mask:0xf bank_mask:0xf
    v_add_f32_dpp v100, v100, v100 quad_perm:[2,3,0,1] row_mask:0xf bank_mask:0xf
    v_add_f32_dpp v101, v101, v101 quad_perm:[2,3,0,1] row_mask:0xf bank_mask:0xf
    v_add_f32_dpp v96, v96, v96 row_half_mirror row_mask:0xf bank_mask:0xf
    v_add_f32_dpp v97, v97, v97 row_half_mirror row_mask:0xf bank_mask:0xf
    v_add_f32_dpp v98, v98, v98 row_half_mirror row_mask:0xf bank_mask:0xf
    v_add_f32_dpp v100, v100, v100 row_half_mirror row_mask:0xf bank_mask:0xf
    v_add_f32_dpp v101, v101, v101 row_half_mirror row_mask:0xf bank_mask:0xf
    v_add_f32 v32, v32, v64
    v_add_f32 v33, v33, v65
    v_add_f32 v34, v34, v66
    v_add_f32 v36, v36, v68
    v_add_f32 v37, v37, v69
    v_add_f32 v38, v38, v70
    v_add_f32 v40, v40, v72
    v_add_f32 v41, v41, v73
    v_add_f32 v42, v42, v74
    v_add_f32 v44, v44, v76
    v_add_f32 v45, v45, v77
    v_add_f32 v46, v46, v78
    v_add_f32 v48, v48, v80
    v_add_f32 v49, v49, v81
    v_add_f32 v50, v50, v82
    v_add_f32 v52, v52, v84
    v_add_f32 v53, v53, v85
    v_add_f32 v54, v54, v86
    v_add_f32 v56, v56, v88
    v_add_f32 v57, v57, v89
    v_add_f32 v58, v58, v90
    v_add_f32 v60, v60, v92
    v_add_f32 v61, v61, v93
    v_add_f32 v62, v62, v94
    v_add_f32 v32, v32, v48
    v_add_f32 v33, v33, v49
    v_add_f32 v34, v34, v50
    v_add_f32 v36, v36, v52
    v_add_f32 v37, v37, v53
    v_add_f32 v38, v38, v54
    v_add_f32 v40, v40, v56
    v_add_f32 v41, v41, v57
    v_add_f32 v42, v42, v58
    v_add_f32 v44, v44, v60
    v_add_f32 v45, v45, v61
    v_add_f32 v46, v46, v62
    v_add_f32 v32, v32, v40
    v_add_f32 v33, v33, v41
    v_add_f32 v34, v34, v42
    v_add_f32 v36, v36, v44
    v_add_f32 v37, v37, v45
    v_add_f32 v38, v38, v46
    v_mul_f32 v32, 0x3b000000, v32
    v_mul_f32 v33, 0x3b000000, v33
    v_mul_f32 v34, 0x3b000000, v34
    v_mul_f32 v36, 0x3b000000, v36
    v_mul_f32 v37, 0x3b000000, v37
    v_mul_f32 v38, 0x3b000000, v38
    v_mul_f32 v96, 0x3b000000, v96
    v_mul_f32 v97, 0x3b000000, v97
    v_mul_f32 v98, 0x3b000000, v98
    v_mul_f32 v100, 0x3b000000, v100
    v_mul_f32 v101, 0x3b000000, v101
    v_fma_f32 v41, -v32, v32, v33
    v_max_f32_e64 v41, 0, v41
    v_add_f32 v41, 0x3727c5ac, v41
    v_rsq_f32_e64 v72, v41
    v_fma_f32 v73, -v32, v96, v34
    v_fma_f32 v74, -v32, v98, v38
    v_fma_f32 v75, v32, v97, -v37
    v_sub_f32_e64 v75, v75, v37
    v_fma_f32 v75, v32, v75, v36
    v_fma_f32 v73, v72, v73, v100
    v_add_f32_e64 v74, v74, v74
    v_fma_f32 v75, v72, v75, v74
    v_fma_f32 v75, v72, v75, v101
    v_fma_f32 v75, -v73, v73, v75
    v_max_f32_e64 v75, 0, v75
    v_add_f32 v75, 0x3727c5ac, v75
    v_rsq_f32 v76, v75
    v_sub_f32 v40, 0, v32
    v_rcp_f32 v41, v72
    v_mul_f32 v77, v72, v76
    v_mul_f32 v42, -v73, v41
    v_rcp_f32 v43, v77
    v_mul_f32 v106, v10, v77
    v_mul_f32 v104, v77, v77
    v_mul_f32 v104, v104, v77
    v_mul_f32 v104, v22, v104
    v_mov_b32 v105, v43
    v_mov_b32_e64 v107, s50
    v_cvt_pk_bf16_f32 v48, v40, v40
    v_and_b32 v48, 0xffff0000, v48
    v_sub_f32_e64 v44, v40, v48
    v_cvt_pk_bf16_f32 v48, v41, v41
    v_and_b32 v48, 0xffff0000, v48
    v_sub_f32_e64 v45, v41, v48
    v_cvt_pk_bf16_f32 v48, v42, v42
    v_and_b32 v48, 0xffff0000, v48
    v_sub_f32_e64 v46, v42, v48
    v_cvt_pk_bf16_f32 v48, v43, v43
    v_and_b32 v48, 0xffff0000, v48
    v_sub_f32_e64 v47, v43, v48
    v_cvt_pk_bf16_f32 v52, v40, v40
    v_cvt_pk_bf16_f32 v53, v44, v41
    v_cvt_pk_bf16_f32 v54, v41, v45
    v_cvt_pk_bf16_f32 v55, v42, v42
    v_cvt_pk_bf16_f32 v56, v46, v43
    v_cvt_pk_bf16_f32 v57, v47, 0
    v_mov_b32 v58, 0
    v_mov_b32 v59, 0
    v_and_b32_e64 v60, 32, v1
    v_lshl_add_u32 v60, v60, 4, v2
    ds_write_b128 v60, v[52:55] offset:0
    ds_write_b128 v60, v[56:59] offset:512
    s_nop 0
    v_add_u32 v60, 162816, v2
    ds_write_b128 v60, v[104:107]
    s_waitcnt lgkmcnt(0)
    s_setprio 0
    s_cmp_lg_u32 s2, 0
    s_cbranch_scc1 L_P5END
    s_mov_b32 s52, 8192
    s_mov_b32 s101, 0
    v_lshlrev_b32_e64 v37, 9, v1
L_BUMPC:
    buffer_load_dword v32, v37, s[12:15], s52 offen offset:0 sc1
    buffer_load_dword v33, v37, s[12:15], s52 offen offset:128 sc1
    buffer_load_dword v34, v37, s[12:15], s52 offen offset:256 sc1
    buffer_load_dword v35, v37, s[12:15], s52 offen offset:384 sc1
    s_add_u32 s101, s101, 1
    s_cmp_gt_u32 s101, 131072
    s_cbranch_scc1 L_BUMPK
    s_waitcnt vmcnt(0)
    v_xor_b32 v32, s50, v32
    v_xor_b32 v33, s50, v33
    v_xor_b32 v34, s50, v34
    v_xor_b32 v35, s50, v35
    v_or_b32 v32, v32, v33
    v_or3_b32 v32, v32, v34, v35
    v_cmp_ne_u32 vcc, 0, v32
    s_nop 0
    s_cbranch_vccnz L_BUMPC
L_BUMPK:
    s_add_u32 s52, s100, 1
    v_mov_b32 v36, s52
    s_mov_b64 exec, 1
    buffer_store_dword v36, v2, s[12:15], 0 offen sc1
    s_mov_b64 exec, -1
    s_branch L_P5END
L_AGR:
    s_nop 4
    s_add_u32 s101, s101, 1
    s_cmp_gt_u32 s101, 131072
    s_cbranch_scc1 L_AGK
    buffer_load_dwordx4 v[88:91], v2, s[12:15], s54 offen offset:0 sc1
    buffer_load_dwordx4 v[92:95], v2, s[12:15], s54 offen offset:1024 sc1
    s_waitcnt vmcnt(0)
    s_branch L_AGC
L_AUR:
    s_nop 4
    s_add_u32 s101, s101, 1
    s_cmp_gt_u32 s101, 131072
    s_cbranch_scc1 L_AUK
    s_sleep 1
    ds_read_b128 v[64:67], v21
    ds_read_b128 v[68:71], v21 offset:512
    ds_read_b128 v[80:83], v2 offset:0
    ds_read_b128 v[84:87], v2 offset:1024
    s_branch L_AUC
SLOW_15:
    s_nop 4
    buffer_store_dword v28, v2, s[12:15], s52 offen sc1
    s_nop 1
    s_branch JOIN_16
L_P6OWN:
    s_nop 4
    s_cmp_eq_u32 s51, 0
    s_cbranch_scc1 SLOW_15
    buffer_store_dword v28, v2, s[12:15], s52 offen
JOIN_16:
    s_mov_b64 exec, -1
    s_nop 0
    v_add_u32 v29, 131072, v2
    ds_read_b128 v[96:99], v29 offset:0
    ds_read_b128 v[100:103], v29 offset:1024
    ds_read_b128 v[104:107], v29 offset:2048
    ds_read_b128 v[108:111], v29 offset:3072
    ds_read_b128 v[112:115], v29 offset:4096
    s_waitcnt lgkmcnt(4)
    v_mfma_f32_32x32x16_bf16 v[32:47], v[128:131], v[96:99], 0
    v_mfma_f32_32x32x16_bf16 v[48:63], v[132:135], v[96:99], 0
    ds_read_b128 v[116:119], v29 offset:5120
    s_waitcnt lgkmcnt(4)
    v_mfma_f32_32x32x16_bf16 v[32:47], v[136:139], v[100:103], v[32:47]
    v_mfma_f32_32x32x16_bf16 v[48:63], v[140:143], v[100:103], v[48:63]
    ds_read_b128 v[120:123], v29 offset:6144
    s_waitcnt lgkmcnt(4)
    v_mfma_f32_32x32x16_bf16 v[32:47], v[144:147], v[104:107], v[32:47]
    v_mfma_f32_32x32x16_bf16 v[48:63], v[148:151], v[104:107], v[48:63]
    ds_read_b128 v[124:127], v29 offset:7168
    s_waitcnt lgkmcnt(4)
    v_mfma_f32_32x32x16_bf16 v[32:47], v[152:155], v[108:111], v[32:47]
    v_mfma_f32_32x32x16_bf16 v[48:63], v[156:159], v[108:111], v[48:63]
    ds_read_b128 v[96:99], v29 offset:8192
    s_waitcnt lgkmcnt(4)
    v_mfma_f32_32x32x16_bf16 v[32:47], v[160:163], v[112:115], v[32:47]
    v_mfma_f32_32x32x16_bf16 v[48:63], v[164:167], v[112:115], v[48:63]
    ds_read_b128 v[100:103], v29 offset:9216
    s_waitcnt lgkmcnt(4)
    v_mfma_f32_32x32x16_bf16 v[32:47], v[168:171], v[116:119], v[32:47]
    v_mfma_f32_32x32x16_bf16 v[48:63], v[172:175], v[116:119], v[48:63]
    ds_read_b128 v[104:107], v29 offset:10240
    s_waitcnt lgkmcnt(4)
    v_mfma_f32_32x32x16_bf16 v[32:47], v[176:179], v[120:123], v[32:47]
    v_mfma_f32_32x32x16_bf16 v[48:63], v[180:183], v[120:123], v[48:63]
    ds_read_b128 v[108:111], v29 offset:11264
    s_waitcnt lgkmcnt(4)
    v_mfma_f32_32x32x16_bf16 v[32:47], v[184:187], v[124:127], v[32:47]
    v_mfma_f32_32x32x16_bf16 v[48:63], v[188:191], v[124:127], v[48:63]
    ds_read_b128 v[112:115], v29 offset:12288
    s_waitcnt lgkmcnt(4)
    v_mfma_f32_32x32x16_bf16 v[32:47], v[192:195], v[96:99], v[32:47]
    v_mfma_f32_32x32x16_bf16 v[48:63], v[196:199], v[96:99], v[48:63]
    ds_read_b128 v[116:119], v29 offset:13312
    s_waitcnt lgkmcnt(4)
    v_mfma_f32_32x32x16_bf16 v[32:47], v[200:203], v[100:103], v[32:47]
    v_mfma_f32_32x32x16_bf16 v[48:63], v[204:207], v[100:103], v[48:63]
    ds_read_b128 v[120:123], v29 offset:14336
    s_waitcnt lgkmcnt(4)
    v_mfma_f32_32x32x16_bf16 v[32:47], v[208:211], v[104:107], v[32:47]
    v_mfma_f32_32x32x16_bf16 v[48:63], v[212:215], v[104:107], v[48:63]
    ds_read_b128 v[124:127], v29 offset:15360
    s_waitcnt lgkmcnt(4)
    v_mfma_f32_32x32x16_bf16 v[32:47], v[216:219], v[108:111], v[32:47]
    v_mfma_f32_32x32x16_bf16 v[48:63], v[220:223], v[108:111], v[48:63]
    ds_read_b128 v[96:99], v29 offset:16384
    s_waitcnt lgkmcnt(4)
    v_mfma_f32_32x32x16_bf16 v[32:47], v[224:227], v[112:115], v[32:47]
    v_mfma_f32_32x32x16_bf16 v[48:63], v[228:231], v[112:115], v[48:63]
    ds_read_b128 v[100:103], v29 offset:17408
    s_waitcnt lgkmcnt(4)
    v_mfma_f32_32x32x16_bf16 v[32:47], v[232:235], v[116:119], v[32:47]
    v_mfma_f32_32x32x16_bf16 v[48:63], v[236:239], v[116:119], v[48:63]
    ds_read_b128 v[104:107], v29 offset:18432
    s_waitcnt lgkmcnt(4)
    v_mfma_f32_32x32x16_bf16 v[64:79], v[128:131], v[120:123], 0
    v_mfma_f32_32x32x16_bf16 v[80:95], v[132:135], v[120:123], 0
    ds_read_b128 v[108:111], v29 offset:19456
    s_waitcnt lgkmcnt(4)
    v_mfma_f32_32x32x16_bf16 v[64:79], v[136:139], v[124:127], v[64:79]
    v_mfma_f32_32x32x16_bf16 v[80:95], v[140:143], v[124:127], v[80:95]
    ds_read_b128 v[112:115], v29 offset:20480
    s_waitcnt lgkmcnt(4)
    v_mfma_f32_32x32x16_bf16 v[64:79], v[144:147], v[96:99], v[64:79]
    v_mfma_f32_32x32x16_bf16 v[80:95], v[148:151], v[96:99], v[80:95]
    ds_read_b128 v[116:119], v29 offset:21504
    s_waitcnt lgkmcnt(4)
    v_mfma_f32_32x32x16_bf16 v[64:79], v[152:155], v[100:103], v[64:79]
    v_mfma_f32_32x32x16_bf16 v[80:95], v[156:159], v[100:103], v[80:95]
    ds_read_b128 v[120:123], v29 offset:22528
    s_waitcnt lgkmcnt(4)
    v_mfma_f32_32x32x16_bf16 v[64:79], v[160:163], v[104:107], v[64:79]
    v_mfma_f32_32x32x16_bf16 v[80:95], v[164:167], v[104:107], v[80:95]
    ds_read_b128 v[124:127], v29 offset:23552
    s_waitcnt lgkmcnt(4)
    v_mfma_f32_32x32x16_bf16 v[64:79], v[168:171], v[108:111], v[64:79]
    v_mfma_f32_32x32x16_bf16 v[80:95], v[172:175], v[108:111], v[80:95]
    s_waitcnt lgkmcnt(0)
    s_nop 0
    ds_write_b128 v4, v[32:35] offset:0
    ds_write_b128 v5, v[36:39] offset:0
    ds_write_b128 v6, v[40:43] offset:0
    ds_write_b128 v7, v[44:47] offset:0
    ds_write_b128 v8, v[48:51] offset:0
    ds_write_b128 v9, v[52:55] offset:0
    ds_write_b128 v10, v[56:59] offset:0
    ds_write_b128 v11, v[60:63] offset:0
    s_waitcnt lgkmcnt(0)
    ds_read_b128 v[96:99], v29 offset:24576
    s_waitcnt lgkmcnt(4)
    v_mfma_f32_32x32x16_bf16 v[64:79], v[176:179], v[112:115], v[64:79]
    v_mfma_f32_32x32x16_bf16 v[80:95], v[180:183], v[112:115], v[80:95]
    ds_read_b128 v[100:103], v29 offset:25600
    s_waitcnt lgkmcnt(4)
    v_mfma_f32_32x32x16_bf16 v[64:79], v[184:187], v[116:119], v[64:79]
    v_mfma_f32_32x32x16_bf16 v[80:95], v[188:191], v[116:119], v[80:95]
    ds_read_b128 v[104:107], v29 offset:26624
    s_waitcnt lgkmcnt(4)
    v_mfma_f32_32x32x16_bf16 v[64:79], v[192:195], v[120:123], v[64:79]
    v_mfma_f32_32x32x16_bf16 v[80:95], v[196:199], v[120:123], v[80:95]
    ds_read_b128 v[108:111], v29 offset:27648
    s_waitcnt lgkmcnt(4)
    v_mfma_f32_32x32x16_bf16 v[64:79], v[200:203], v[124:127], v[64:79]
    v_mfma_f32_32x32x16_bf16 v[80:95], v[204:207], v[124:127], v[80:95]
    s_waitcnt lgkmcnt(3)
    v_mfma_f32_32x32x16_bf16 v[64:79], v[208:211], v[96:99], v[64:79]
    v_mfma_f32_32x32x16_bf16 v[80:95], v[212:215], v[96:99], v[80:95]
    s_waitcnt lgkmcnt(2)
    v_mfma_f32_32x32x16_bf16 v[64:79], v[216:219], v[100:103], v[64:79]
    v_mfma_f32_32x32x16_bf16 v[80:95], v[220:223], v[100:103], v[80:95]
    s_waitcnt lgkmcnt(1)
    v_mfma_f32_32x32x16_bf16 v[64:79], v[224:227], v[104:107], v[64:79]
    v_mfma_f32_32x32x16_bf16 v[80:95], v[228:231], v[104:107], v[80:95]
    s_waitcnt lgkmcnt(0)
    v_mfma_f32_32x32x16_bf16 v[64:79], v[232:235], v[108:111], v[64:79]
    v_mfma_f32_32x32x16_bf16 v[80:95], v[236:239], v[108:111], v[80:95]
    s_nop 7
    s_nop 3
    s_branch L_P6J
L_CODE_END:
.section .rodata,"a"
.p2align 6
.amdhsa_kernel adaLN_cond__sliding_block__mixer_channel_mlp__prompt_kernel
  .amdhsa_next_free_vgpr 256
  .amdhsa_next_free_sgpr 102
  .amdhsa_accum_offset 256
  .amdhsa_group_segment_fixed_size 0
  .amdhsa_kernarg_size 104
  .amdhsa_user_sgpr_count 2
  .amdhsa_user_sgpr_kernarg_segment_ptr 1
  .amdhsa_system_sgpr_workgroup_id_x 1
.end_amdhsa_kernel
```
